```python
import torch

def _softmax(x, axis=-1):
    return torch.softmax(x, dim=axis)

def _gelu(x):
    return torch.nn.functional.gelu(x, approximate='tanh')

def _silu(x):
    return torch.nn.functional.silu(x)

def _sigmoid(x):
    return torch.sigmoid(x)

def _layernorm(x, axis=-1, eps=1e-05):
    m = x.mean(dim=axis, keepdim=True)
    v = x.var(dim=axis, keepdim=True, unbiased=False)
    return (x - m) / torch.sqrt(v + eps)

def _scatter_add(tgt, idx, src, axis=0):
    return tgt.clone().index_add_(axis, idx, src)

def _segment_sum(src, seg, n):
    out = torch.zeros((n,) + src.shape[1:], dtype=src.dtype)
    return out.index_add_(0, seg, src)

def _pad(x, pw):
    flat = tuple((v for pair in reversed(pw) for v in pair))
    return torch.nn.functional.pad(x, flat)
kernel_name = 'standalone__factorization_afm__recsys'

def setup_inputs():

    _w = lambda a: (lambda t: t.to(torch.bfloat16) if t.is_floating_point() else t)(torch.as_tensor(a))
    B, F, D, V = (4096, 26, 128, min(1000000, 100000))
    A = D
    ii, jj = tuple(torch.triu_indices(F, F, 1).unbind(0))
    return {'idx': _w((lambda lo, hi, *s: torch.randint(lo, hi, s))(0, V, B, F).to(torch.int64)), 'table': _w((lambda *s: torch.randn(*s, dtype=torch.bfloat16) * 0.2)(V, D)), 'ii': _w(ii.to(torch.int64)), 'jj': _w(jj.to(torch.int64)), 'W': _w((lambda *s: torch.randn(*s, dtype=torch.bfloat16) * 1.6)(D, A) * (1.0 / D ** 0.5)), 'b': _w((lambda *s: torch.randn(*s, dtype=torch.bfloat16) * 1.6)(A)), 'h': _w((lambda *s: torch.randn(*s, dtype=torch.bfloat16) * 1.6)(A)), 'p': _w((lambda *s: torch.randn(*s, dtype=torch.bfloat16) * 0.2)(D))}

def reference(idx, table, ii, jj, W, b, h, p):
    emb = table[idx]
    ei = emb[:, ii, :].clone()
    ej = emb[:, jj, :].clone()
    pair = ei * ej
    hid = pair @ W + b
    hid = 0.5 * (hid + torch.abs(hid))
    e = hid @ h
    alpha = _softmax(e, axis=-1)
    pooled = torch.einsum('bp,bpd->bd', alpha, pair)
    return pooled @ p
```

```asm
; @launch grid=(256,1,1) block=(256,1,1) lds=67584
.amdgcn_target "amdgcn-amd-amdhsa--gfx950"
.text
.globl standalone__factorization_afm__recsys_kernel
.p2align 8
.type standalone__factorization_afm__recsys_kernel,@function
standalone__factorization_afm__recsys_kernel:
    s_load_dwordx4 s[4:7], s[0:1], 0
    s_load_dwordx8 s[8:15], s[0:1], 32
    s_load_dwordx2 s[16:17], s[0:1], 64
    s_cmp_ge_u32 s2, 256
    s_cbranch_scc1 L_end
    s_getpc_b64 s[56:57]
    v_lshrrev_b32 v248, 3, v0
    s_bfe_u32 s3, s2, 0x30003
    v_lshlrev_b32 v248, 7, v248
    s_mul_i32 s3, s3, 3072
    v_add_u32 v248, s3, v248
    v_lshrrev_b32 v247, 6, v0
    global_load_dword v241, v248, s[56:57]
    v_readfirstlane_b32 s32, v247
    v_and_b32 v213, 15, v0
    v_and_b32 v212, 63, v0
    v_lshlrev_b32 v243, 2, v213
    s_mov_b32 s22, 425984
    s_mov_b32 s23, 0x20000
    s_lshl_b32 s42, s2, 2
    s_add_u32 s42, s42, s32
    s_mul_i32 s48, s42, 416
    v_lshlrev_b32 v171, 13, v247
    v_lshl_add_u32 v171, v212, 4, v171
    v_add_u32 v172, 0x1000, v171
    v_lshlrev_b32 v254, 4, v213
    v_lshlrev_b32 v249, 2, v212
    v_lshrrev_b32 v214, 4, v212
    s_mov_b32 s26, 25600000
    s_mov_b32 s27, 0x20000
    v_lshlrev_b32 v246, 6, v214
    v_mul_u32_u24 v164, 544, v214
    s_lshl_b32 s49, s32, 14
    s_and_b32 s54, s32, 1
    s_lshl_b32 s55, s54, 7
    s_add_u32 s49, s49, s55
    v_add3_u32 v164, v164, v254, s49
    s_cmp_eq_u32 s32, 1
    s_cbranch_scc1 L_fp
    s_cmp_ge_u32 s32, 2
    s_cbranch_scc1 L_fz2
    v_mul_u32_u24 v162, 160, v214
    v_bfe_u32 v253, v212, 2, 1
    v_mul_u32_u24 v253, 80, v253
    v_add_u32 v162, v162, v253
    v_bfe_u32 v253, v212, 0, 1
    v_lshl_add_u32 v162, v253, 4, v162
    v_bfe_u32 v253, v212, 1, 1
    v_lshl_add_u32 v162, v253, 3, v162
    v_bfe_u32 v253, v212, 3, 1
    v_lshl_add_u32 v162, v253, 2, v162
    v_add_u32 v162, 66176, v162
    s_branch L_fd
L_fp:
    v_lshrrev_b32 v253, 2, v213
    v_mul_u32_u24 v162, 160, v253
    v_bfe_u32 v253, v212, 5, 1
    v_mul_u32_u24 v253, 80, v253
    v_add_u32 v162, v162, v253
    v_bfe_u32 v253, v212, 0, 1
    v_lshl_add_u32 v162, v253, 4, v162
    v_bfe_u32 v253, v212, 4, 1
    v_lshl_add_u32 v162, v253, 3, v162
    v_bfe_u32 v253, v212, 1, 1
    v_lshl_add_u32 v162, v253, 2, v162
    v_add_u32 v162, 65568, v162
    s_branch L_fd
L_fz2:
    v_lshlrev_b32 v162, 3, v212
    v_add_u32 v162, 66816, v162
    s_cmp_eq_u32 s32, 2
    s_cbranch_scc1 L_fd
    v_or_b32 v253, 8, v213
    v_cmp_eq_u32 vcc, 0, v214
    v_add_u32 v252, 1, v214
    v_mov_b64 v[204:205], 0
    v_mov_b64 v[206:207], 0
    v_cndmask_b32 v253, v253, v213, vcc
    v_cndmask_b32 v252, v252, 4, vcc
    v_mul_u32_u24 v162, 80, v253
    v_lshl_add_u32 v162, v252, 4, v162
    v_add_u32 v162, 65536, v162
    ds_write_b128 v162, v[204:207]
    v_mov_b32 v162, 67328
L_fd:
    s_waitcnt lgkmcnt(0)
    s_mov_b32 s20, s4
    s_mov_b32 s21, s5
    buffer_load_dword v238, v243, s[20:23], s48 offen
    global_load_dwordx4 v[180:183], v254, s[10:11]
    global_load_dwordx4 v[176:179], v254, s[12:13]
    global_load_dwordx4 v[64:67], v171, s[8:9] offset:0
    global_load_dwordx4 v[68:71], v171, s[8:9] offset:1024
    s_cmp_eq_u32 s32, 0
    s_cselect_b64 s[18:19], s[12:13], s[14:15]
    s_cmp_eq_u32 s32, 2
    s_cselect_b64 s[18:19], s[10:11], s[18:19]
    global_load_dword v161, v249, s[18:19]
    global_load_dwordx4 v[72:75], v171, s[8:9] offset:2048
    global_load_dwordx4 v[76:79], v171, s[8:9] offset:3072
    global_load_dwordx4 v[80:83], v172, s[8:9] offset:0
    global_load_dwordx4 v[84:87], v172, s[8:9] offset:1024
    global_load_dwordx4 v[88:91], v172, s[8:9] offset:2048
    global_load_dwordx4 v[92:95], v172, s[8:9] offset:3072
    s_mov_b32 s24, s6
    s_mov_b32 s25, s7
    s_mov_b32 s44, 0x79123514
    s_mov_b32 s45, 0x9328465
    s_mov_b32 s46, 0x8695782
    s_mov_b32 s47, 0x13960374
    v_lshrrev_b64 v[192:193], v243, s[44:45]
    v_lshrrev_b64 v[194:195], v243, s[46:47]
    v_and_b32 v192, 15, v192
    v_and_b32 v194, 15, v194
    v_lshl_add_u32 v244, v192, 2, 64
    v_lshl_add_u32 v245, v194, 2, 64
    v_lshrrev_b32 v248, 2, v213
    v_mul_u32_u24 v165, 544, v248
    v_lshl_add_u32 v165, v214, 14, v165
    v_and_b32 v250, 1, v214
    v_lshl_add_u32 v165, v250, 7, v165
    v_and_b32 v251, 3, v213
    v_lshl_add_u32 v165, v251, 3, v165
    v_mul_u32_u24 v255, 80, v214
    v_add_u32 v255, 65536, v255
    v_lshl_add_u32 v252, v251, 4, v255
    v_add_u32 v253, 64, v255
    v_cmp_eq_u32 s[44:45], 0, v248
    v_cmp_eq_u32 s[46:47], 1, v248
    v_cmp_eq_u32 s[60:61], 2, v248
    v_cmp_eq_u32 s[62:63], 3, v248
    v_cndmask_b32 v166, v253, v252, s[44:45]
    v_cndmask_b32 v167, v253, v252, s[46:47]
    v_cndmask_b32 v168, v253, v252, s[60:61]
    v_cndmask_b32 v169, v253, v252, s[62:63]
    v_lshlrev_b32 v170, 4, v214
    v_add_u32 v170, 66816, v170
    v_mul_u32_u24 v163, 160, v248
    v_lshrrev_b32 v252, 1, v214
    v_lshl_add_u32 v163, v252, 4, v163
    v_lshl_add_u32 v163, v250, 1, v163
    s_lshr_b32 s55, s32, 1
    s_mul_i32 s55, s55, 80
    s_lshl_b32 s54, s54, 3
    s_add_u32 s55, s55, s54
    s_add_u32 s55, s55, 65536
    v_add_u32 v163, s55, v163
    v_and_b32 v252, 1, v212
    v_mul_u32_u24 v242, 0xaaaa, v252
    v_add_u32 v242, 0x4444, v242
    v_mov_b32 v208, 0xff800000
    s_mov_b32 s28, s16
    s_mov_b32 s29, s17
    s_mov_b32 s30, 8192
    s_mov_b32 s31, 0x20000
    s_add_u32 s33, s48, 104
    s_mov_b32 s34, 0
    s_mov_b32 s36, 0x00ff00ff
    s_mov_b32 s37, 0x00ff00ff
    s_mov_b32 s38, 0x40000000
    s_mov_b32 s39, 0x4002000
    s_mov_b32 s40, 0x3f38aa3b
    s_mov_b32 s41, 0xffff0000
    buffer_load_dword v239, v244, s[20:23], s48 offen
    buffer_load_dword v240, v245, s[20:23], s48 offen
    s_waitcnt vmcnt(13)
    v_lshl_add_u32 v238, v238, 8, v246
    buffer_load_dwordx4 v[4:7], v238, s[24:27], 0 offen offset:0
    buffer_load_dwordx4 v[12:15], v238, s[24:27], 0 offen offset:16
    buffer_load_dwordx4 v[20:23], v238, s[24:27], 0 offen offset:32
    buffer_load_dwordx4 v[28:31], v238, s[24:27], 0 offen offset:48
    s_waitcnt vmcnt(15)
    v_and_b32 v180, 0x80008000, v180
    v_and_b32 v181, 0x80008000, v181
    v_and_b32 v182, 0x80008000, v182
    v_and_b32 v183, 0x80008000, v183
    v_xor_b32 v176, v176, v180
    v_xor_b32 v177, v177, v181
    v_xor_b32 v178, v178, v182
    v_xor_b32 v179, v179, v183
    s_waitcnt vmcnt(12)
    s_cmp_eq_u32 s32, 2
    s_cbranch_scc1 L_wb
    ds_write_b32 v162, v161
    s_branch L_wd
L_wb:
    v_and_b32 v161, 0x7fff7fff, v161
    v_lshlrev_b32 v160, 16, v161
    v_and_b32 v161, s41, v161
    ds_write_b64 v162, v[160:161]
L_wd:
    s_waitcnt vmcnt(14)
    v_xor_b32 v64, v64, v180
    v_xor_b32 v65, v65, v181
    v_xor_b32 v66, v66, v182
    v_xor_b32 v67, v67, v183
    s_waitcnt vmcnt(13)
    v_xor_b32 v68, v68, v180
    v_xor_b32 v69, v69, v181
    v_xor_b32 v70, v70, v182
    v_xor_b32 v71, v71, v183
    s_waitcnt vmcnt(11)
    v_xor_b32 v72, v72, v180
    v_xor_b32 v73, v73, v181
    v_xor_b32 v74, v74, v182
    v_xor_b32 v75, v75, v183
    s_waitcnt vmcnt(10)
    v_xor_b32 v76, v76, v180
    v_xor_b32 v77, v77, v181
    v_xor_b32 v78, v78, v182
    v_xor_b32 v79, v79, v183
    ds_write_b128 v164, v[64:67] offset:0
    ds_write_b128 v164, v[68:71] offset:2048
    ds_write_b128 v164, v[72:75] offset:4096
    ds_write_b128 v164, v[76:79] offset:6144
    v_dot2_f32_bf16 v144, v64, v176, 0
    v_dot2_f32_bf16 v145, v68, v176, 0
    v_dot2_f32_bf16 v146, v72, v176, 0
    v_dot2_f32_bf16 v147, v76, v176, 0
    v_dot2_f32_bf16 v144, v65, v177, v144
    v_dot2_f32_bf16 v145, v69, v177, v145
    v_dot2_f32_bf16 v146, v73, v177, v146
    v_dot2_f32_bf16 v147, v77, v177, v147
    v_dot2_f32_bf16 v144, v66, v178, v144
    v_dot2_f32_bf16 v145, v70, v178, v145
    v_dot2_f32_bf16 v146, v74, v178, v146
    v_dot2_f32_bf16 v147, v78, v178, v147
    v_dot2_f32_bf16 v144, v67, v179, v144
    v_dot2_f32_bf16 v145, v71, v179, v145
    v_dot2_f32_bf16 v146, v75, v179, v146
    v_dot2_f32_bf16 v147, v79, v179, v147
    s_waitcnt vmcnt(9)
    v_xor_b32 v80, v80, v180
    v_xor_b32 v81, v81, v181
    v_xor_b32 v82, v82, v182
    v_xor_b32 v83, v83, v183
    s_waitcnt vmcnt(8)
    v_xor_b32 v84, v84, v180
    v_xor_b32 v85, v85, v181
    v_xor_b32 v86, v86, v182
    v_xor_b32 v87, v87, v183
    s_waitcnt vmcnt(7)
    v_xor_b32 v88, v88, v180
    v_xor_b32 v89, v89, v181
    v_xor_b32 v90, v90, v182
    v_xor_b32 v91, v91, v183
    s_waitcnt vmcnt(6)
    v_xor_b32 v92, v92, v180
    v_xor_b32 v93, v93, v181
    v_xor_b32 v94, v94, v182
    v_xor_b32 v95, v95, v183
    ds_write_b128 v164, v[80:83] offset:8192
    ds_write_b128 v164, v[84:87] offset:10240
    ds_write_b128 v164, v[88:91] offset:12288
    ds_write_b128 v164, v[92:95] offset:14336
    v_dot2_f32_bf16 v148, v80, v176, 0
    v_dot2_f32_bf16 v149, v84, v176, 0
    v_dot2_f32_bf16 v150, v88, v176, 0
    v_dot2_f32_bf16 v151, v92, v176, 0
    v_dot2_f32_bf16 v148, v81, v177, v148
    v_dot2_f32_bf16 v149, v85, v177, v149
    v_dot2_f32_bf16 v150, v89, v177, v150
    v_dot2_f32_bf16 v151, v93, v177, v151
    v_dot2_f32_bf16 v148, v82, v178, v148
    v_dot2_f32_bf16 v149, v86, v178, v149
    v_dot2_f32_bf16 v150, v90, v178, v150
    v_dot2_f32_bf16 v151, v94, v178, v151
    v_dot2_f32_bf16 v148, v83, v179, v148
    v_dot2_f32_bf16 v149, v87, v179, v149
    v_dot2_f32_bf16 v150, v91, v179, v150
    v_dot2_f32_bf16 v151, v95, v179, v151
    v_add_f32_dpp v144, v144, v144 row_ror:8 row_mask:0xf bank_mask:0x3
    v_add_f32_dpp v145, v145, v145 row_ror:8 row_mask:0xf bank_mask:0x3
    v_add_f32_dpp v146, v146, v146 row_ror:8 row_mask:0xf bank_mask:0x3
    v_add_f32_dpp v147, v147, v147 row_ror:8 row_mask:0xf bank_mask:0x3
    v_add_f32_dpp v144, v148, v148 row_ror:8 row_mask:0xf bank_mask:0xc
    v_add_f32_dpp v145, v149, v149 row_ror:8 row_mask:0xf bank_mask:0xc
    v_add_f32_dpp v146, v150, v150 row_ror:8 row_mask:0xf bank_mask:0xc
    v_add_f32_dpp v147, v151, v151 row_ror:8 row_mask:0xf bank_mask:0xc
    v_add_f32_dpp v148, v144, v144 row_half_mirror row_mask:0xf bank_mask:0x5
    v_add_f32_dpp v149, v145, v145 row_half_mirror row_mask:0xf bank_mask:0x5
    v_add_f32_dpp v148, v146, v146 row_half_mirror row_mask:0xf bank_mask:0xa
    v_add_f32_dpp v149, v147, v147 row_half_mirror row_mask:0xf bank_mask:0xa
    v_mov_b64 v[200:201], 0
    v_add_f32_dpp v148, v148, v148 quad_perm:[1,0,3,2] row_mask:0xf bank_mask:0xf
    v_add_f32_dpp v149, v149, v149 quad_perm:[1,0,3,2] row_mask:0xf bank_mask:0xf
    v_mov_b64 v[202:203], 0
    v_add_f32_dpp v148, v148, v148 quad_perm:[2,3,0,1] row_mask:0xf bank_mask:0xf
    v_add_f32_dpp v149, v149, v149 quad_perm:[2,3,0,1] row_mask:0xf bank_mask:0xf
    v_cvt_pk_bf16_f32 v148, v148, v149
    ds_write_b16 v163, v148
    ds_write_b16_d16_hi v163, v148 offset:4
    s_waitcnt lgkmcnt(0)
    s_barrier
    ds_read_b128 v[96:99], v170 offset:0
    ds_read_b64_tr_b16 a[0:1], v165 offset:0
    ds_read_b64_tr_b16 a[2:3], v165 offset:2048
    ds_read_b64_tr_b16 a[4:5], v165 offset:4096
    ds_read_b64_tr_b16 a[6:7], v165 offset:6144
    ds_read_b64_tr_b16 a[8:9], v165 offset:8192
    ds_read_b64_tr_b16 a[10:11], v165 offset:10240
    ds_read_b64_tr_b16 a[12:13], v165 offset:12288
    ds_read_b64_tr_b16 a[14:15], v165 offset:14336
    ds_read_b128 v[100:103], v170 offset:64
    ds_read_b64_tr_b16 a[16:17], v165 offset:32
    ds_read_b64_tr_b16 a[18:19], v165 offset:2080
    ds_read_b64_tr_b16 a[20:21], v165 offset:4128
    ds_read_b64_tr_b16 a[22:23], v165 offset:6176
    ds_read_b64_tr_b16 a[24:25], v165 offset:8224
    ds_read_b64_tr_b16 a[26:27], v165 offset:10272
    ds_read_b64_tr_b16 a[28:29], v165 offset:12320
    ds_read_b64_tr_b16 a[30:31], v165 offset:14368
    ds_read_b128 v[104:107], v170 offset:128
    ds_read_b64_tr_b16 a[32:33], v165 offset:64
    ds_read_b64_tr_b16 a[34:35], v165 offset:2112
    ds_read_b64_tr_b16 a[36:37], v165 offset:4160
    ds_read_b64_tr_b16 a[38:39], v165 offset:6208
    ds_read_b64_tr_b16 a[40:41], v165 offset:8256
    ds_read_b64_tr_b16 a[42:43], v165 offset:10304
    ds_read_b64_tr_b16 a[44:45], v165 offset:12352
    ds_read_b64_tr_b16 a[46:47], v165 offset:14400
    ds_read_b128 v[108:111], v170 offset:192
    ds_read_b64_tr_b16 a[48:49], v165 offset:96
    ds_read_b64_tr_b16 a[50:51], v165 offset:2144
    ds_read_b64_tr_b16 a[52:53], v165 offset:4192
    ds_read_b64_tr_b16 a[54:55], v165 offset:6240
    ds_read_b64_tr_b16 a[56:57], v165 offset:8288
    ds_read_b64_tr_b16 a[58:59], v165 offset:10336
    ds_read_b64_tr_b16 a[60:61], v165 offset:12384
    ds_read_b64_tr_b16 a[62:63], v165 offset:14432
    ds_read_b128 v[112:115], v170 offset:256
    ds_read_b64_tr_b16 a[64:65], v165 offset:128
    ds_read_b64_tr_b16 a[66:67], v165 offset:2176
    ds_read_b64_tr_b16 a[68:69], v165 offset:4224
    ds_read_b64_tr_b16 a[70:71], v165 offset:6272
    ds_read_b64_tr_b16 a[72:73], v165 offset:8320
    ds_read_b64_tr_b16 a[74:75], v165 offset:10368
    ds_read_b64_tr_b16 a[76:77], v165 offset:12416
    ds_read_b64_tr_b16 a[78:79], v165 offset:14464
    s_waitcnt vmcnt(3)
    v_lshlrev_b32 v0, 16, v4
    v_and_b32 v4, s41, v4
    v_lshlrev_b32 v1, 16, v5
    v_and_b32 v5, s41, v5
    v_lshlrev_b32 v2, 16, v6
    v_and_b32 v6, s41, v6
    v_lshlrev_b32 v3, 16, v7
    v_and_b32 v7, s41, v7
    v_lshl_add_u32 v239, v239, 8, v246
    v_mul_f32_dpp v204, v0, v0 row_ror:1 row_mask:0xf bank_mask:0xf
    v_mul_f32_dpp v205, v4, v4 row_ror:1 row_mask:0xf bank_mask:0xf
    v_mul_f32_dpp v206, v1, v1 row_ror:1 row_mask:0xf bank_mask:0xf
    v_mul_f32_dpp v207, v5, v5 row_ror:1 row_mask:0xf bank_mask:0xf
    v_cvt_pk_bf16_f32 v128, v204, v205
    v_cvt_pk_bf16_f32 v129, v206, v207
    v_mul_f32_dpp v204, v2, v2 row_ror:1 row_mask:0xf bank_mask:0xf
    v_mul_f32_dpp v205, v6, v6 row_ror:1 row_mask:0xf bank_mask:0xf
    v_mul_f32_dpp v206, v3, v3 row_ror:1 row_mask:0xf bank_mask:0xf
    v_mul_f32_dpp v207, v7, v7 row_ror:1 row_mask:0xf bank_mask:0xf
    v_cvt_pk_bf16_f32 v130, v204, v205
    v_cvt_pk_bf16_f32 v131, v206, v207
    ds_read_b128 v[116:119], v170 offset:320
    ds_read_b64_tr_b16 a[80:81], v165 offset:160
    ds_read_b64_tr_b16 a[82:83], v165 offset:2208
    ds_read_b64_tr_b16 a[84:85], v165 offset:4256
    ds_read_b64_tr_b16 a[86:87], v165 offset:6304
    ds_read_b64_tr_b16 a[88:89], v165 offset:8352
    ds_read_b64_tr_b16 a[90:91], v165 offset:10400
    ds_read_b64_tr_b16 a[92:93], v165 offset:12448
    ds_read_b64_tr_b16 a[94:95], v165 offset:14496
    s_waitcnt vmcnt(2)
    v_lshlrev_b32 v8, 16, v12
    v_and_b32 v12, s41, v12
    v_lshlrev_b32 v9, 16, v13
    v_and_b32 v13, s41, v13
    v_lshlrev_b32 v10, 16, v14
    v_and_b32 v14, s41, v14
    v_lshlrev_b32 v11, 16, v15
    v_and_b32 v15, s41, v15
    v_lshl_add_u32 v240, v240, 8, v246
    v_mul_f32_dpp v204, v8, v8 row_ror:1 row_mask:0xf bank_mask:0xf
    v_mul_f32_dpp v205, v12, v12 row_ror:1 row_mask:0xf bank_mask:0xf
    v_mul_f32_dpp v206, v9, v9 row_ror:1 row_mask:0xf bank_mask:0xf
    v_mul_f32_dpp v207, v13, v13 row_ror:1 row_mask:0xf bank_mask:0xf
    v_cvt_pk_bf16_f32 v132, v204, v205
    v_cvt_pk_bf16_f32 v133, v206, v207
    v_mul_f32_dpp v204, v10, v10 row_ror:1 row_mask:0xf bank_mask:0xf
    v_mul_f32_dpp v205, v14, v14 row_ror:1 row_mask:0xf bank_mask:0xf
    v_mul_f32_dpp v206, v11, v11 row_ror:1 row_mask:0xf bank_mask:0xf
    v_mul_f32_dpp v207, v15, v15 row_ror:1 row_mask:0xf bank_mask:0xf
    v_cvt_pk_bf16_f32 v134, v204, v205
    v_cvt_pk_bf16_f32 v135, v206, v207
    ds_read_b128 v[120:123], v170 offset:384
    ds_read_b64_tr_b16 a[96:97], v165 offset:192
    ds_read_b64_tr_b16 a[98:99], v165 offset:2240
    ds_read_b64_tr_b16 a[100:101], v165 offset:4288
    ds_read_b64_tr_b16 a[102:103], v165 offset:6336
    ds_read_b64_tr_b16 a[104:105], v165 offset:8384
    ds_read_b64_tr_b16 a[106:107], v165 offset:10432
    ds_read_b64_tr_b16 a[108:109], v165 offset:12480
    ds_read_b64_tr_b16 a[110:111], v165 offset:14528
    s_waitcnt vmcnt(1)
    v_lshlrev_b32 v16, 16, v20
    v_and_b32 v20, s41, v20
    v_lshlrev_b32 v17, 16, v21
    v_and_b32 v21, s41, v21
    v_lshlrev_b32 v18, 16, v22
    v_and_b32 v22, s41, v22
    v_lshlrev_b32 v19, 16, v23
    v_and_b32 v23, s41, v23
    s_nop 0
    v_mul_f32_dpp v204, v16, v16 row_ror:1 row_mask:0xf bank_mask:0xf
    v_mul_f32_dpp v205, v20, v20 row_ror:1 row_mask:0xf bank_mask:0xf
    v_mul_f32_dpp v206, v17, v17 row_ror:1 row_mask:0xf bank_mask:0xf
    v_mul_f32_dpp v207, v21, v21 row_ror:1 row_mask:0xf bank_mask:0xf
    v_cvt_pk_bf16_f32 v136, v204, v205
    v_cvt_pk_bf16_f32 v137, v206, v207
    v_mul_f32_dpp v204, v18, v18 row_ror:1 row_mask:0xf bank_mask:0xf
    v_mul_f32_dpp v205, v22, v22 row_ror:1 row_mask:0xf bank_mask:0xf
    v_mul_f32_dpp v206, v19, v19 row_ror:1 row_mask:0xf bank_mask:0xf
    v_mul_f32_dpp v207, v23, v23 row_ror:1 row_mask:0xf bank_mask:0xf
    v_cvt_pk_bf16_f32 v138, v204, v205
    v_cvt_pk_bf16_f32 v139, v206, v207
    ds_read_b128 v[124:127], v170 offset:448
    ds_read_b64_tr_b16 a[112:113], v165 offset:224
    ds_read_b64_tr_b16 a[114:115], v165 offset:2272
    ds_read_b64_tr_b16 a[116:117], v165 offset:4320
    ds_read_b64_tr_b16 a[118:119], v165 offset:6368
    ds_read_b64_tr_b16 a[120:121], v165 offset:8416
    ds_read_b64_tr_b16 a[122:123], v165 offset:10464
    ds_read_b64_tr_b16 a[124:125], v165 offset:12512
    ds_read_b64_tr_b16 a[126:127], v165 offset:14560
    s_waitcnt vmcnt(0)
    v_lshlrev_b32 v24, 16, v28
    v_and_b32 v28, s41, v28
    v_lshlrev_b32 v25, 16, v29
    v_and_b32 v29, s41, v29
    v_lshlrev_b32 v26, 16, v30
    v_and_b32 v30, s41, v30
    v_lshlrev_b32 v27, 16, v31
    v_and_b32 v31, s41, v31
    s_nop 0
    v_mul_f32_dpp v204, v24, v24 row_ror:1 row_mask:0xf bank_mask:0xf
    v_mul_f32_dpp v205, v28, v28 row_ror:1 row_mask:0xf bank_mask:0xf
    v_mul_f32_dpp v206, v25, v25 row_ror:1 row_mask:0xf bank_mask:0xf
    v_mul_f32_dpp v207, v29, v29 row_ror:1 row_mask:0xf bank_mask:0xf
    v_cvt_pk_bf16_f32 v140, v204, v205
    v_cvt_pk_bf16_f32 v141, v206, v207
    v_mul_f32_dpp v204, v26, v26 row_ror:1 row_mask:0xf bank_mask:0xf
    v_mul_f32_dpp v205, v30, v30 row_ror:1 row_mask:0xf bank_mask:0xf
    v_mul_f32_dpp v206, v27, v27 row_ror:1 row_mask:0xf bank_mask:0xf
    v_mul_f32_dpp v207, v31, v31 row_ror:1 row_mask:0xf bank_mask:0xf
    v_cvt_pk_bf16_f32 v142, v204, v205
    v_cvt_pk_bf16_f32 v143, v206, v207
    s_waitcnt lgkmcnt(15)
    v_mfma_f32_16x16x32_bf16 v[192:195], a[0:3], v[128:131], v[96:99]
    v_mul_f32_dpp v204, v0, v0 row_ror:2 row_mask:0xf bank_mask:0xf
    v_mul_f32_dpp v205, v4, v4 row_ror:2 row_mask:0xf bank_mask:0xf
    v_mfma_f32_16x16x32_bf16 v[192:195], a[4:7], v[132:135], v[192:195]
    v_mul_f32_dpp v206, v1, v1 row_ror:2 row_mask:0xf bank_mask:0xf
    v_mul_f32_dpp v207, v5, v5 row_ror:2 row_mask:0xf bank_mask:0xf
    v_mfma_f32_16x16x32_bf16 v[192:195], a[8:11], v[136:139], v[192:195]
    v_mul_f32_dpp v64, v0, v0 row_ror:8 row_mask:0xf bank_mask:0xf
    v_mul_f32_dpp v65, v1, v1 row_ror:8 row_mask:0xf bank_mask:0xf
    v_mfma_f32_16x16x32_bf16 v[192:195], a[12:15], v[140:143], v[192:195]
    ds_read_b128 a[128:131], v166 offset:0
    ds_read_b128 a[132:135], v166 offset:320
    ds_read_b128 a[136:139], v166 offset:640
    ds_read_b128 a[140:143], v166 offset:960
    ds_read_b128 a[144:147], v167 offset:0
    ds_read_b128 a[148:151], v167 offset:320
    ds_read_b128 a[152:155], v167 offset:640
    ds_read_b128 a[156:159], v167 offset:960
    buffer_load_dword v238, v243, s[20:23], s33 offen
    v_cvt_pk_bf16_f32 v144, v204, v205
    v_cvt_pk_bf16_f32 v145, v206, v207
    v_mfma_f32_16x16x32_bf16 v[196:199], a[28:31], v[140:143], v[100:103]
    v_mul_f32_dpp v204, v2, v2 row_ror:2 row_mask:0xf bank_mask:0xf
    v_mul_f32_dpp v205, v6, v6 row_ror:2 row_mask:0xf bank_mask:0xf
    v_mfma_f32_16x16x32_bf16 v[196:199], a[24:27], v[136:139], v[196:199]
    v_mul_f32_dpp v206, v3, v3 row_ror:2 row_mask:0xf bank_mask:0xf
    v_mul_f32_dpp v207, v7, v7 row_ror:2 row_mask:0xf bank_mask:0xf
    v_mfma_f32_16x16x32_bf16 v[196:199], a[20:23], v[132:135], v[196:199]
    v_cvt_pk_bf16_f32 v176, |v192|, |v193|
    v_cvt_pk_bf16_f32 v177, |v194|, |v195|
    v_mfma_f32_16x16x32_bf16 v[196:199], a[16:19], v[128:131], v[196:199]
    ds_read_b128 a[160:163], v168 offset:0
    ds_read_b128 a[164:167], v168 offset:320
    ds_read_b128 a[168:171], v168 offset:640
    ds_read_b128 a[172:175], v168 offset:960
    ds_read_b128 a[176:179], v169 offset:0
    ds_read_b128 a[180:183], v169 offset:320
    ds_read_b128 a[184:187], v169 offset:640
    ds_read_b128 a[188:191], v169 offset:960
    buffer_load_dwordx4 v[36:39], v239, s[24:27], 0 offen offset:0
    v_cvt_pk_bf16_f32 v146, v204, v205
    v_cvt_pk_bf16_f32 v147, v206, v207
    v_mfma_f32_16x16x32_bf16 v[192:195], a[32:35], v[128:131], v[104:107]
    v_mul_f32_dpp v204, v8, v8 row_ror:2 row_mask:0xf bank_mask:0xf
    v_mul_f32_dpp v205, v12, v12 row_ror:2 row_mask:0xf bank_mask:0xf
    v_mfma_f32_16x16x32_bf16 v[192:195], a[36:39], v[132:135], v[192:195]
    v_mul_f32_dpp v206, v9, v9 row_ror:2 row_mask:0xf bank_mask:0xf
    v_mul_f32_dpp v207, v13, v13 row_ror:2 row_mask:0xf bank_mask:0xf
    v_mfma_f32_16x16x32_bf16 v[192:195], a[40:43], v[136:139], v[192:195]
    v_cvt_pk_bf16_f32 v178, |v196|, |v197|
    v_cvt_pk_bf16_f32 v179, |v198|, |v199|
    v_mfma_f32_16x16x32_bf16 v[192:195], a[44:47], v[140:143], v[192:195]
    v_cvt_pk_bf16_f32 v148, v204, v205
    v_cvt_pk_bf16_f32 v149, v206, v207
    v_mfma_f32_16x16x32_bf16 v[196:199], a[60:63], v[140:143], v[108:111]
    v_mul_f32_dpp v204, v10, v10 row_ror:2 row_mask:0xf bank_mask:0xf
    v_mul_f32_dpp v205, v14, v14 row_ror:2 row_mask:0xf bank_mask:0xf
    v_mfma_f32_16x16x32_bf16 v[196:199], a[56:59], v[136:139], v[196:199]
    v_mul_f32_dpp v206, v11, v11 row_ror:2 row_mask:0xf bank_mask:0xf
    v_mul_f32_dpp v207, v15, v15 row_ror:2 row_mask:0xf bank_mask:0xf
    v_mfma_f32_16x16x32_bf16 v[196:199], a[52:55], v[132:135], v[196:199]
    v_cvt_pk_bf16_f32 v180, |v192|, |v193|
    v_cvt_pk_bf16_f32 v181, |v194|, |v195|
    v_mfma_f32_16x16x32_bf16 v[196:199], a[48:51], v[128:131], v[196:199]
    buffer_load_dwordx4 v[44:47], v239, s[24:27], 0 offen offset:16
    v_cvt_pk_bf16_f32 v150, v204, v205
    v_cvt_pk_bf16_f32 v151, v206, v207
    v_mfma_f32_16x16x32_bf16 v[192:195], a[64:67], v[128:131], v[112:115]
    v_mul_f32_dpp v204, v16, v16 row_ror:2 row_mask:0xf bank_mask:0xf
    v_mul_f32_dpp v205, v20, v20 row_ror:2 row_mask:0xf bank_mask:0xf
    v_mfma_f32_16x16x32_bf16 v[192:195], a[68:71], v[132:135], v[192:195]
    v_mul_f32_dpp v206, v17, v17 row_ror:2 row_mask:0xf bank_mask:0xf
    v_mul_f32_dpp v207, v21, v21 row_ror:2 row_mask:0xf bank_mask:0xf
    v_mfma_f32_16x16x32_bf16 v[192:195], a[72:75], v[136:139], v[192:195]
    v_cvt_pk_bf16_f32 v182, |v196|, |v197|
    v_cvt_pk_bf16_f32 v183, |v198|, |v199|
    v_mfma_f32_16x16x32_bf16 v[192:195], a[76:79], v[140:143], v[192:195]
    v_cvt_pk_bf16_f32 v152, v204, v205
    v_cvt_pk_bf16_f32 v153, v206, v207
    v_mfma_f32_16x16x32_bf16 v[196:199], a[92:95], v[140:143], v[116:119]
    v_mul_f32_dpp v204, v18, v18 row_ror:2 row_mask:0xf bank_mask:0xf
    v_mul_f32_dpp v205, v22, v22 row_ror:2 row_mask:0xf bank_mask:0xf
    v_mfma_f32_16x16x32_bf16 v[196:199], a[88:91], v[136:139], v[196:199]
    v_mul_f32_dpp v206, v19, v19 row_ror:2 row_mask:0xf bank_mask:0xf
    v_mul_f32_dpp v207, v23, v23 row_ror:2 row_mask:0xf bank_mask:0xf
    v_mfma_f32_16x16x32_bf16 v[196:199], a[84:87], v[132:135], v[196:199]
    v_cvt_pk_bf16_f32 v184, |v192|, |v193|
    v_cvt_pk_bf16_f32 v185, |v194|, |v195|
    v_mfma_f32_16x16x32_bf16 v[196:199], a[80:83], v[128:131], v[196:199]
    buffer_load_dwordx4 v[52:55], v239, s[24:27], 0 offen offset:32
    v_cvt_pk_bf16_f32 v154, v204, v205
    v_cvt_pk_bf16_f32 v155, v206, v207
    s_waitcnt lgkmcnt(15)
    v_mfma_f32_16x16x32_bf16 v[192:195], a[96:99], v[128:131], v[120:123]
    v_mul_f32_dpp v204, v24, v24 row_ror:2 row_mask:0xf bank_mask:0xf
    v_mul_f32_dpp v205, v28, v28 row_ror:2 row_mask:0xf bank_mask:0xf
    v_mfma_f32_16x16x32_bf16 v[192:195], a[100:103], v[132:135], v[192:195]
    v_mul_f32_dpp v206, v25, v25 row_ror:2 row_mask:0xf bank_mask:0xf
    v_mul_f32_dpp v207, v29, v29 row_ror:2 row_mask:0xf bank_mask:0xf
    v_mfma_f32_16x16x32_bf16 v[192:195], a[104:107], v[136:139], v[192:195]
    v_cvt_pk_bf16_f32 v186, |v196|, |v197|
    v_cvt_pk_bf16_f32 v187, |v198|, |v199|
    v_mfma_f32_16x16x32_bf16 v[192:195], a[108:111], v[140:143], v[192:195]
    buffer_load_dwordx4 v[60:63], v239, s[24:27], 0 offen offset:48
    v_cvt_pk_bf16_f32 v156, v204, v205
    v_cvt_pk_bf16_f32 v157, v206, v207
    v_mfma_f32_16x16x32_bf16 v[196:199], a[124:127], v[140:143], v[124:127]
    v_mul_f32_dpp v204, v26, v26 row_ror:2 row_mask:0xf bank_mask:0xf
    v_mul_f32_dpp v205, v30, v30 row_ror:2 row_mask:0xf bank_mask:0xf
    v_mfma_f32_16x16x32_bf16 v[196:199], a[120:123], v[136:139], v[196:199]
    v_mul_f32_dpp v206, v27, v27 row_ror:2 row_mask:0xf bank_mask:0xf
    v_mul_f32_dpp v207, v31, v31 row_ror:2 row_mask:0xf bank_mask:0xf
    v_mfma_f32_16x16x32_bf16 v[196:199], a[116:119], v[132:135], v[196:199]
    v_cvt_pk_bf16_f32 v188, |v192|, |v193|
    v_cvt_pk_bf16_f32 v189, |v194|, |v195|
    v_mfma_f32_16x16x32_bf16 v[196:199], a[112:115], v[128:131], v[196:199]
    buffer_load_dword v239, v244, s[20:23], s33 offen
    v_cvt_pk_bf16_f32 v158, v204, v205
    v_cvt_pk_bf16_f32 v159, v206, v207
    s_waitcnt lgkmcnt(0)
    v_smfmac_f32_16x16x64_bf16 v[200:203], a[128:131], v[128:135], v242
    v_smfmac_f32_16x16x64_bf16 v[200:203], a[132:135], v[136:143], v242
    s_branch L_T1
.p2align 6
L_T0:
    v_mfma_f32_16x16x32_bf16 v[192:195], a[0:3], v[128:131], v[96:99]
    v_mul_f32_dpp v204, v0, v0 row_ror:2 row_mask:0xf bank_mask:0xf
    v_mul_f32_dpp v205, v4, v4 row_ror:2 row_mask:0xf bank_mask:0xf
    v_mfma_f32_16x16x32_bf16 v[192:195], a[4:7], v[132:135], v[192:195]
    v_mul_f32_dpp v206, v1, v1 row_ror:2 row_mask:0xf bank_mask:0xf
    v_mul_f32_dpp v207, v5, v5 row_ror:2 row_mask:0xf bank_mask:0xf
    v_mfma_f32_16x16x32_bf16 v[192:195], a[8:11], v[136:139], v[192:195]
    v_cvt_pk_bf16_f32 v190, |v196|, |v197|
    v_cvt_pk_bf16_f32 v191, |v198|, |v199|
    v_mfma_f32_16x16x32_bf16 v[192:195], a[12:15], v[140:143], v[192:195]
    v_cvt_pk_bf16_f32 v144, v204, v205
    v_cvt_pk_bf16_f32 v145, v206, v207
    v_smfmac_f32_16x16x64_bf16 v[200:203], a[184:187], v[176:183], v242
    v_mul_f32_dpp v64, v0, v0 row_ror:8 row_mask:0xf bank_mask:0xf
    v_smfmac_f32_16x16x64_bf16 v[200:203], a[188:191], v[184:191], v242
    v_mul_f32_dpp v65, v1, v1 row_ror:8 row_mask:0xf bank_mask:0xf
    v_mfma_f32_16x16x32_bf16 v[196:199], a[28:31], v[140:143], v[100:103]
    v_mul_f32_dpp v204, v2, v2 row_ror:2 row_mask:0xf bank_mask:0xf
    v_mul_f32_dpp v205, v6, v6 row_ror:2 row_mask:0xf bank_mask:0xf
    v_mfma_f32_16x16x32_bf16 v[196:199], a[24:27], v[136:139], v[196:199]
    v_mul_f32_dpp v206, v3, v3 row_ror:2 row_mask:0xf bank_mask:0xf
    v_mul_f32_dpp v207, v7, v7 row_ror:2 row_mask:0xf bank_mask:0xf
    v_mfma_f32_16x16x32_bf16 v[196:199], a[20:23], v[132:135], v[196:199]
    v_cvt_pk_bf16_f32 v176, |v192|, |v193|
    v_cvt_pk_bf16_f32 v177, |v194|, |v195|
    v_mfma_f32_16x16x32_bf16 v[196:199], a[16:19], v[128:131], v[196:199]
    v_add_f32 v216, v200, v201
    v_add_f32 v221, v202, v203
    v_mov_b64 v[200:201], 0
    v_mov_b64 v[202:203], 0
    v_cvt_pk_bf16_f32 v146, v204, v205
    v_cvt_pk_bf16_f32 v147, v206, v207
    v_smfmac_f32_16x16x64_bf16 v[200:203], a[128:131], v[128:135], v242
    v_cndmask_b32 v216, v216, v208, s[38:39]
    v_smfmac_f32_16x16x64_bf16 v[200:203], a[132:135], v[136:143], v242
    v_max3_f32 v222, v212, v213, v214
    v_max3_f32 v222, v222, v215, v216
    v_mul_f32 v222, s40, v222
    v_mfma_f32_16x16x32_bf16 v[192:195], a[32:35], v[128:131], v[104:107]
    v_mul_f32_dpp v204, v8, v8 row_ror:2 row_mask:0xf bank_mask:0xf
    v_mul_f32_dpp v205, v12, v12 row_ror:2 row_mask:0xf bank_mask:0xf
    v_mfma_f32_16x16x32_bf16 v[192:195], a[36:39], v[132:135], v[192:195]
    v_mul_f32_dpp v206, v9, v9 row_ror:2 row_mask:0xf bank_mask:0xf
    v_mul_f32_dpp v207, v13, v13 row_ror:2 row_mask:0xf bank_mask:0xf
    v_mfma_f32_16x16x32_bf16 v[192:195], a[40:43], v[136:139], v[192:195]
    v_cvt_pk_bf16_f32 v178, |v196|, |v197|
    v_cvt_pk_bf16_f32 v179, |v198|, |v199|
    v_mfma_f32_16x16x32_bf16 v[192:195], a[44:47], v[140:143], v[192:195]
    v_cvt_pk_bf16_f32 v148, v204, v205
    v_cvt_pk_bf16_f32 v149, v206, v207
    v_fma_f32 v212, v212, s40, -v222
    v_fma_f32 v213, v213, s40, -v222
    v_fma_f32 v214, v214, s40, -v222
    v_fma_f32 v215, v215, s40, -v222
    v_fma_f32 v216, v216, s40, -v222
    v_exp_f32 v212, v212
    v_exp_f32 v213, v213
    v_exp_f32 v214, v214
    v_exp_f32 v215, v215
    v_exp_f32 v216, v216
    v_mfma_f32_16x16x32_bf16 v[196:199], a[60:63], v[140:143], v[108:111]
    v_mul_f32_dpp v204, v10, v10 row_ror:2 row_mask:0xf bank_mask:0xf
    v_mul_f32_dpp v205, v14, v14 row_ror:2 row_mask:0xf bank_mask:0xf
    v_mfma_f32_16x16x32_bf16 v[196:199], a[56:59], v[136:139], v[196:199]
    v_mul_f32_dpp v206, v11, v11 row_ror:2 row_mask:0xf bank_mask:0xf
    v_mul_f32_dpp v207, v15, v15 row_ror:2 row_mask:0xf bank_mask:0xf
    v_mfma_f32_16x16x32_bf16 v[196:199], a[52:55], v[132:135], v[196:199]
    v_cvt_pk_bf16_f32 v180, |v192|, |v193|
    v_cvt_pk_bf16_f32 v181, |v194|, |v195|
    v_mfma_f32_16x16x32_bf16 v[196:199], a[48:51], v[128:131], v[196:199]
    v_cvt_pk_bf16_f32 v150, v204, v205
    v_cvt_pk_bf16_f32 v151, v206, v207
    v_add_f32 v223, v212, v213
    v_mul_f32 v224, v212, v217
    v_add_f32 v223, v223, v214
    v_add_f32 v223, v223, v215
    v_add_f32 v223, v223, v216
    v_fmac_f32 v224, v213, v218
    v_fmac_f32 v224, v214, v219
    v_fmac_f32 v224, v215, v220
    v_fmac_f32 v224, v216, v221
    v_mfma_f32_16x16x32_bf16 v[192:195], a[64:67], v[128:131], v[112:115]
    v_mul_f32_dpp v204, v16, v16 row_ror:2 row_mask:0xf bank_mask:0xf
    v_mul_f32_dpp v205, v20, v20 row_ror:2 row_mask:0xf bank_mask:0xf
    v_mfma_f32_16x16x32_bf16 v[192:195], a[68:71], v[132:135], v[192:195]
    v_mul_f32_dpp v206, v17, v17 row_ror:2 row_mask:0xf bank_mask:0xf
    v_mul_f32_dpp v207, v21, v21 row_ror:2 row_mask:0xf bank_mask:0xf
    v_mfma_f32_16x16x32_bf16 v[192:195], a[72:75], v[136:139], v[192:195]
    v_cvt_pk_bf16_f32 v182, |v196|, |v197|
    v_cvt_pk_bf16_f32 v183, |v198|, |v199|
    v_mfma_f32_16x16x32_bf16 v[192:195], a[76:79], v[140:143], v[192:195]
    v_cvt_pk_bf16_f32 v152, v204, v205
    v_cvt_pk_bf16_f32 v153, v206, v207
    v_mfma_f32_16x16x32_bf16 v[196:199], a[92:95], v[140:143], v[116:119]
    v_mul_f32_dpp v204, v18, v18 row_ror:2 row_mask:0xf bank_mask:0xf
    v_mul_f32_dpp v205, v22, v22 row_ror:2 row_mask:0xf bank_mask:0xf
    v_mfma_f32_16x16x32_bf16 v[196:199], a[88:91], v[136:139], v[196:199]
    v_mul_f32_dpp v206, v19, v19 row_ror:2 row_mask:0xf bank_mask:0xf
    v_mul_f32_dpp v207, v23, v23 row_ror:2 row_mask:0xf bank_mask:0xf
    v_mfma_f32_16x16x32_bf16 v[196:199], a[84:87], v[132:135], v[196:199]
    v_cvt_pk_bf16_f32 v184, |v192|, |v193|
    v_cvt_pk_bf16_f32 v185, |v194|, |v195|
    v_mfma_f32_16x16x32_bf16 v[196:199], a[80:83], v[128:131], v[196:199]
    v_cvt_pk_bf16_f32 v154, v204, v205
    v_cvt_pk_bf16_f32 v155, v206, v207
    v_mfma_f32_16x16x32_bf16 v[192:195], a[96:99], v[128:131], v[120:123]
    v_mul_f32_dpp v204, v24, v24 row_ror:2 row_mask:0xf bank_mask:0xf
    v_mul_f32_dpp v205, v28, v28 row_ror:2 row_mask:0xf bank_mask:0xf
    v_mfma_f32_16x16x32_bf16 v[192:195], a[100:103], v[132:135], v[192:195]
    v_mul_f32_dpp v206, v25, v25 row_ror:2 row_mask:0xf bank_mask:0xf
    v_mul_f32_dpp v207, v29, v29 row_ror:2 row_mask:0xf bank_mask:0xf
    v_mfma_f32_16x16x32_bf16 v[192:195], a[104:107], v[136:139], v[192:195]
    v_cvt_pk_bf16_f32 v186, |v196|, |v197|
    v_cvt_pk_bf16_f32 v187, |v198|, |v199|
    v_mfma_f32_16x16x32_bf16 v[192:195], a[108:111], v[140:143], v[192:195]
    v_cvt_pk_bf16_f32 v156, v204, v205
    v_cvt_pk_bf16_f32 v157, v206, v207
    v_mfma_f32_16x16x32_bf16 v[196:199], a[124:127], v[140:143], v[124:127]
    v_mul_f32_dpp v204, v26, v26 row_ror:2 row_mask:0xf bank_mask:0xf
    v_mul_f32_dpp v205, v30, v30 row_ror:2 row_mask:0xf bank_mask:0xf
    v_mfma_f32_16x16x32_bf16 v[196:199], a[120:123], v[136:139], v[196:199]
    v_mul_f32_dpp v206, v27, v27 row_ror:2 row_mask:0xf bank_mask:0xf
    v_mul_f32_dpp v207, v31, v31 row_ror:2 row_mask:0xf bank_mask:0xf
    v_mfma_f32_16x16x32_bf16 v[196:199], a[116:119], v[132:135], v[196:199]
    v_cvt_pk_bf16_f32 v188, |v192|, |v193|
    v_cvt_pk_bf16_f32 v189, |v194|, |v195|
    v_mfma_f32_16x16x32_bf16 v[196:199], a[112:115], v[128:131], v[196:199]
    v_cvt_pk_bf16_f32 v158, v204, v205
    v_cvt_pk_bf16_f32 v159, v206, v207
L_T1:
    v_mfma_f32_16x16x32_bf16 v[192:195], a[0:3], v[144:147], v[96:99]
    v_mul_f32_dpp v204, v0, v0 row_ror:3 row_mask:0xf bank_mask:0xf
    v_mul_f32_dpp v205, v4, v4 row_ror:3 row_mask:0xf bank_mask:0xf
    v_mfma_f32_16x16x32_bf16 v[192:195], a[4:7], v[148:151], v[192:195]
    v_mul_f32_dpp v206, v1, v1 row_ror:3 row_mask:0xf bank_mask:0xf
    v_mul_f32_dpp v207, v5, v5 row_ror:3 row_mask:0xf bank_mask:0xf
    v_mfma_f32_16x16x32_bf16 v[192:195], a[8:11], v[152:155], v[192:195]
    v_cvt_pk_bf16_f32 v190, |v196|, |v197|
    v_cvt_pk_bf16_f32 v191, |v198|, |v199|
    v_mfma_f32_16x16x32_bf16 v[192:195], a[12:15], v[156:159], v[192:195]
    v_cvt_pk_bf16_f32 v128, v204, v205
    v_cvt_pk_bf16_f32 v129, v206, v207
    v_smfmac_f32_16x16x64_bf16 v[200:203], a[136:139], v[176:183], v242
    v_mul_f32_dpp v66, v2, v2 row_ror:8 row_mask:0xf bank_mask:0xf
    v_smfmac_f32_16x16x64_bf16 v[200:203], a[140:143], v[184:191], v242
    v_mul_f32_dpp v67, v3, v3 row_ror:8 row_mask:0xf bank_mask:0xf
    v_smfmac_f32_16x16x64_bf16 v[200:203], a[144:147], v[144:151], v242
    v_mul_f32_dpp v68, v4, v4 row_ror:8 row_mask:0xf bank_mask:0xf
    v_smfmac_f32_16x16x64_bf16 v[200:203], a[148:151], v[152:159], v242
    v_mul_f32_dpp v69, v5, v5 row_ror:8 row_mask:0xf bank_mask:0xf
    v_mfma_f32_16x16x32_bf16 v[196:199], a[28:31], v[156:159], v[100:103]
    v_mul_f32_dpp v204, v2, v2 row_ror:3 row_mask:0xf bank_mask:0xf
    v_mul_f32_dpp v205, v6, v6 row_ror:3 row_mask:0xf bank_mask:0xf
    v_mfma_f32_16x16x32_bf16 v[196:199], a[24:27], v[152:155], v[196:199]
    v_mul_f32_dpp v206, v3, v3 row_ror:3 row_mask:0xf bank_mask:0xf
    v_mul_f32_dpp v207, v7, v7 row_ror:3 row_mask:0xf bank_mask:0xf
    v_mfma_f32_16x16x32_bf16 v[196:199], a[20:23], v[148:151], v[196:199]
    v_cvt_pk_bf16_f32 v176, |v192|, |v193|
    v_cvt_pk_bf16_f32 v177, |v194|, |v195|
    v_mfma_f32_16x16x32_bf16 v[196:199], a[16:19], v[144:147], v[196:199]
    v_cvt_pk_bf16_f32 v130, v204, v205
    v_cvt_pk_bf16_f32 v131, v206, v207
    v_mfma_f32_16x16x32_bf16 v[192:195], a[32:35], v[144:147], v[104:107]
    v_mul_f32_dpp v204, v8, v8 row_ror:3 row_mask:0xf bank_mask:0xf
    v_mul_f32_dpp v205, v12, v12 row_ror:3 row_mask:0xf bank_mask:0xf
    v_mfma_f32_16x16x32_bf16 v[192:195], a[36:39], v[148:151], v[192:195]
    v_mul_f32_dpp v206, v9, v9 row_ror:3 row_mask:0xf bank_mask:0xf
    v_mul_f32_dpp v207, v13, v13 row_ror:3 row_mask:0xf bank_mask:0xf
    v_mfma_f32_16x16x32_bf16 v[192:195], a[40:43], v[152:155], v[192:195]
    v_cvt_pk_bf16_f32 v178, |v196|, |v197|
    v_cvt_pk_bf16_f32 v179, |v198|, |v199|
    v_mfma_f32_16x16x32_bf16 v[192:195], a[44:47], v[156:159], v[192:195]
    v_cvt_pk_bf16_f32 v132, v204, v205
    v_cvt_pk_bf16_f32 v133, v206, v207
    v_mfma_f32_16x16x32_bf16 v[196:199], a[60:63], v[156:159], v[108:111]
    v_mul_f32_dpp v204, v10, v10 row_ror:3 row_mask:0xf bank_mask:0xf
    v_mul_f32_dpp v205, v14, v14 row_ror:3 row_mask:0xf bank_mask:0xf
    v_mfma_f32_16x16x32_bf16 v[196:199], a[56:59], v[152:155], v[196:199]
    v_mul_f32_dpp v206, v11, v11 row_ror:3 row_mask:0xf bank_mask:0xf
    v_mul_f32_dpp v207, v15, v15 row_ror:3 row_mask:0xf bank_mask:0xf
    v_mfma_f32_16x16x32_bf16 v[196:199], a[52:55], v[148:151], v[196:199]
    v_cvt_pk_bf16_f32 v180, |v192|, |v193|
    v_cvt_pk_bf16_f32 v181, |v194|, |v195|
    v_mfma_f32_16x16x32_bf16 v[196:199], a[48:51], v[144:147], v[196:199]
    v_cvt_pk_bf16_f32 v134, v204, v205
    v_cvt_pk_bf16_f32 v135, v206, v207
    v_mfma_f32_16x16x32_bf16 v[192:195], a[64:67], v[144:147], v[112:115]
    v_mul_f32_dpp v204, v16, v16 row_ror:3 row_mask:0xf bank_mask:0xf
    v_mul_f32_dpp v205, v20, v20 row_ror:3 row_mask:0xf bank_mask:0xf
    v_mfma_f32_16x16x32_bf16 v[192:195], a[68:71], v[148:151], v[192:195]
    v_mul_f32_dpp v206, v17, v17 row_ror:3 row_mask:0xf bank_mask:0xf
    v_mul_f32_dpp v207, v21, v21 row_ror:3 row_mask:0xf bank_mask:0xf
    v_mfma_f32_16x16x32_bf16 v[192:195], a[72:75], v[152:155], v[192:195]
    v_cvt_pk_bf16_f32 v182, |v196|, |v197|
    v_cvt_pk_bf16_f32 v183, |v198|, |v199|
    v_mfma_f32_16x16x32_bf16 v[192:195], a[76:79], v[156:159], v[192:195]
    v_cvt_pk_bf16_f32 v136, v204, v205
    v_cvt_pk_bf16_f32 v137, v206, v207
    v_mfma_f32_16x16x32_bf16 v[196:199], a[92:95], v[156:159], v[116:119]
    v_mul_f32_dpp v204, v18, v18 row_ror:3 row_mask:0xf bank_mask:0xf
    v_mul_f32_dpp v205, v22, v22 row_ror:3 row_mask:0xf bank_mask:0xf
    v_mfma_f32_16x16x32_bf16 v[196:199], a[88:91], v[152:155], v[196:199]
    v_mul_f32_dpp v206, v19, v19 row_ror:3 row_mask:0xf bank_mask:0xf
    v_mul_f32_dpp v207, v23, v23 row_ror:3 row_mask:0xf bank_mask:0xf
    v_mfma_f32_16x16x32_bf16 v[196:199], a[84:87], v[148:151], v[196:199]
    v_cvt_pk_bf16_f32 v184, |v192|, |v193|
    v_cvt_pk_bf16_f32 v185, |v194|, |v195|
    v_mfma_f32_16x16x32_bf16 v[196:199], a[80:83], v[144:147], v[196:199]
    v_cvt_pk_bf16_f32 v138, v204, v205
    v_cvt_pk_bf16_f32 v139, v206, v207
    v_mfma_f32_16x16x32_bf16 v[192:195], a[96:99], v[144:147], v[120:123]
    v_mul_f32_dpp v204, v24, v24 row_ror:3 row_mask:0xf bank_mask:0xf
    v_mul_f32_dpp v205, v28, v28 row_ror:3 row_mask:0xf bank_mask:0xf
    v_mfma_f32_16x16x32_bf16 v[192:195], a[100:103], v[148:151], v[192:195]
    v_mul_f32_dpp v206, v25, v25 row_ror:3 row_mask:0xf bank_mask:0xf
    v_mul_f32_dpp v207, v29, v29 row_ror:3 row_mask:0xf bank_mask:0xf
    v_mfma_f32_16x16x32_bf16 v[192:195], a[104:107], v[152:155], v[192:195]
    v_cvt_pk_bf16_f32 v186, |v196|, |v197|
    v_cvt_pk_bf16_f32 v187, |v198|, |v199|
    v_mfma_f32_16x16x32_bf16 v[192:195], a[108:111], v[156:159], v[192:195]
    v_cvt_pk_bf16_f32 v140, v204, v205
    v_cvt_pk_bf16_f32 v141, v206, v207
    v_mfma_f32_16x16x32_bf16 v[196:199], a[124:127], v[156:159], v[124:127]
    v_mul_f32_dpp v204, v26, v26 row_ror:3 row_mask:0xf bank_mask:0xf
    v_mul_f32_dpp v205, v30, v30 row_ror:3 row_mask:0xf bank_mask:0xf
    v_mfma_f32_16x16x32_bf16 v[196:199], a[120:123], v[152:155], v[196:199]
    v_mul_f32_dpp v206, v27, v27 row_ror:3 row_mask:0xf bank_mask:0xf
    v_mul_f32_dpp v207, v31, v31 row_ror:3 row_mask:0xf bank_mask:0xf
    v_mfma_f32_16x16x32_bf16 v[196:199], a[116:119], v[148:151], v[196:199]
    v_cvt_pk_bf16_f32 v188, |v192|, |v193|
    v_cvt_pk_bf16_f32 v189, |v194|, |v195|
    v_mfma_f32_16x16x32_bf16 v[196:199], a[112:115], v[144:147], v[196:199]
    v_cvt_pk_bf16_f32 v142, v204, v205
    v_cvt_pk_bf16_f32 v143, v206, v207
    v_mfma_f32_16x16x32_bf16 v[192:195], a[0:3], v[128:131], v[96:99]
    v_mul_f32_dpp v204, v0, v0 row_ror:4 row_mask:0xf bank_mask:0xf
    v_mul_f32_dpp v205, v4, v4 row_ror:4 row_mask:0xf bank_mask:0xf
    v_mfma_f32_16x16x32_bf16 v[192:195], a[4:7], v[132:135], v[192:195]
    v_mul_f32_dpp v206, v1, v1 row_ror:4 row_mask:0xf bank_mask:0xf
    v_mul_f32_dpp v207, v5, v5 row_ror:4 row_mask:0xf bank_mask:0xf
    v_mfma_f32_16x16x32_bf16 v[192:195], a[8:11], v[136:139], v[192:195]
    v_cvt_pk_bf16_f32 v190, |v196|, |v197|
    v_cvt_pk_bf16_f32 v191, |v198|, |v199|
    v_mfma_f32_16x16x32_bf16 v[192:195], a[12:15], v[140:143], v[192:195]
    v_cvt_pk_bf16_f32 v144, v204, v205
    v_cvt_pk_bf16_f32 v145, v206, v207
    v_smfmac_f32_16x16x64_bf16 v[200:203], a[152:155], v[176:183], v242
    v_mul_f32_dpp v70, v6, v6 row_ror:8 row_mask:0xf bank_mask:0xf
    v_smfmac_f32_16x16x64_bf16 v[200:203], a[156:159], v[184:191], v242
    v_mul_f32_dpp v71, v7, v7 row_ror:8 row_mask:0xf bank_mask:0xf
    v_smfmac_f32_16x16x64_bf16 v[200:203], a[160:163], v[128:135], v242
    v_mul_f32_dpp v72, v8, v8 row_ror:8 row_mask:0xf bank_mask:0xf
    v_smfmac_f32_16x16x64_bf16 v[200:203], a[164:167], v[136:143], v242
    v_mul_f32_dpp v73, v9, v9 row_ror:8 row_mask:0xf bank_mask:0xf
    v_mfma_f32_16x16x32_bf16 v[196:199], a[28:31], v[140:143], v[100:103]
    v_mul_f32_dpp v204, v2, v2 row_ror:4 row_mask:0xf bank_mask:0xf
    v_mul_f32_dpp v205, v6, v6 row_ror:4 row_mask:0xf bank_mask:0xf
    v_mfma_f32_16x16x32_bf16 v[196:199], a[24:27], v[136:139], v[196:199]
    v_mul_f32_dpp v206, v3, v3 row_ror:4 row_mask:0xf bank_mask:0xf
    v_mul_f32_dpp v207, v7, v7 row_ror:4 row_mask:0xf bank_mask:0xf
    v_mfma_f32_16x16x32_bf16 v[196:199], a[20:23], v[132:135], v[196:199]
    v_cvt_pk_bf16_f32 v176, |v192|, |v193|
    v_cvt_pk_bf16_f32 v177, |v194|, |v195|
    v_mfma_f32_16x16x32_bf16 v[196:199], a[16:19], v[128:131], v[196:199]
    v_cvt_pk_bf16_f32 v146, v204, v205
    v_cvt_pk_bf16_f32 v147, v206, v207
    v_mfma_f32_16x16x32_bf16 v[192:195], a[32:35], v[128:131], v[104:107]
    v_mul_f32_dpp v204, v8, v8 row_ror:4 row_mask:0xf bank_mask:0xf
    v_mul_f32_dpp v205, v12, v12 row_ror:4 row_mask:0xf bank_mask:0xf
    v_mfma_f32_16x16x32_bf16 v[192:195], a[36:39], v[132:135], v[192:195]
    v_mul_f32_dpp v206, v9, v9 row_ror:4 row_mask:0xf bank_mask:0xf
    v_mul_f32_dpp v207, v13, v13 row_ror:4 row_mask:0xf bank_mask:0xf
    v_mfma_f32_16x16x32_bf16 v[192:195], a[40:43], v[136:139], v[192:195]
    v_cvt_pk_bf16_f32 v178, |v196|, |v197|
    v_cvt_pk_bf16_f32 v179, |v198|, |v199|
    v_mfma_f32_16x16x32_bf16 v[192:195], a[44:47], v[140:143], v[192:195]
    v_cvt_pk_bf16_f32 v148, v204, v205
    v_cvt_pk_bf16_f32 v149, v206, v207
    v_mfma_f32_16x16x32_bf16 v[196:199], a[60:63], v[140:143], v[108:111]
    v_mul_f32_dpp v204, v10, v10 row_ror:4 row_mask:0xf bank_mask:0xf
    v_mul_f32_dpp v205, v14, v14 row_ror:4 row_mask:0xf bank_mask:0xf
    v_mfma_f32_16x16x32_bf16 v[196:199], a[56:59], v[136:139], v[196:199]
    v_mul_f32_dpp v206, v11, v11 row_ror:4 row_mask:0xf bank_mask:0xf
    v_mul_f32_dpp v207, v15, v15 row_ror:4 row_mask:0xf bank_mask:0xf
    v_mfma_f32_16x16x32_bf16 v[196:199], a[52:55], v[132:135], v[196:199]
    v_cvt_pk_bf16_f32 v180, |v192|, |v193|
    v_cvt_pk_bf16_f32 v181, |v194|, |v195|
    v_mfma_f32_16x16x32_bf16 v[196:199], a[48:51], v[128:131], v[196:199]
    v_cvt_pk_bf16_f32 v150, v204, v205
    v_cvt_pk_bf16_f32 v151, v206, v207
    v_mfma_f32_16x16x32_bf16 v[192:195], a[64:67], v[128:131], v[112:115]
    v_mul_f32_dpp v204, v16, v16 row_ror:4 row_mask:0xf bank_mask:0xf
    v_mul_f32_dpp v205, v20, v20 row_ror:4 row_mask:0xf bank_mask:0xf
    v_mfma_f32_16x16x32_bf16 v[192:195], a[68:71], v[132:135], v[192:195]
    v_mul_f32_dpp v206, v17, v17 row_ror:4 row_mask:0xf bank_mask:0xf
    v_mul_f32_dpp v207, v21, v21 row_ror:4 row_mask:0xf bank_mask:0xf
    v_mfma_f32_16x16x32_bf16 v[192:195], a[72:75], v[136:139], v[192:195]
    v_cvt_pk_bf16_f32 v182, |v196|, |v197|
    v_cvt_pk_bf16_f32 v183, |v198|, |v199|
    v_mfma_f32_16x16x32_bf16 v[192:195], a[76:79], v[140:143], v[192:195]
    v_cvt_pk_bf16_f32 v152, v204, v205
    v_cvt_pk_bf16_f32 v153, v206, v207
    v_mfma_f32_16x16x32_bf16 v[196:199], a[92:95], v[140:143], v[116:119]
    v_mul_f32_dpp v204, v18, v18 row_ror:4 row_mask:0xf bank_mask:0xf
    v_mul_f32_dpp v205, v22, v22 row_ror:4 row_mask:0xf bank_mask:0xf
    v_mfma_f32_16x16x32_bf16 v[196:199], a[88:91], v[136:139], v[196:199]
    v_mul_f32_dpp v206, v19, v19 row_ror:4 row_mask:0xf bank_mask:0xf
    v_mul_f32_dpp v207, v23, v23 row_ror:4 row_mask:0xf bank_mask:0xf
    v_mfma_f32_16x16x32_bf16 v[196:199], a[84:87], v[132:135], v[196:199]
    v_cvt_pk_bf16_f32 v184, |v192|, |v193|
    v_cvt_pk_bf16_f32 v185, |v194|, |v195|
    v_mfma_f32_16x16x32_bf16 v[196:199], a[80:83], v[128:131], v[196:199]
    v_cvt_pk_bf16_f32 v154, v204, v205
    v_cvt_pk_bf16_f32 v155, v206, v207
    v_mfma_f32_16x16x32_bf16 v[192:195], a[96:99], v[128:131], v[120:123]
    v_mul_f32_dpp v204, v24, v24 row_ror:4 row_mask:0xf bank_mask:0xf
    v_mul_f32_dpp v205, v28, v28 row_ror:4 row_mask:0xf bank_mask:0xf
    v_mfma_f32_16x16x32_bf16 v[192:195], a[100:103], v[132:135], v[192:195]
    v_mul_f32_dpp v206, v25, v25 row_ror:4 row_mask:0xf bank_mask:0xf
    v_mul_f32_dpp v207, v29, v29 row_ror:4 row_mask:0xf bank_mask:0xf
    v_mfma_f32_16x16x32_bf16 v[192:195], a[104:107], v[136:139], v[192:195]
    v_cvt_pk_bf16_f32 v186, |v196|, |v197|
    v_cvt_pk_bf16_f32 v187, |v198|, |v199|
    v_mfma_f32_16x16x32_bf16 v[192:195], a[108:111], v[140:143], v[192:195]
    v_cvt_pk_bf16_f32 v156, v204, v205
    v_cvt_pk_bf16_f32 v157, v206, v207
    v_mfma_f32_16x16x32_bf16 v[196:199], a[124:127], v[140:143], v[124:127]
    v_mul_f32_dpp v204, v26, v26 row_ror:4 row_mask:0xf bank_mask:0xf
    v_mul_f32_dpp v205, v30, v30 row_ror:4 row_mask:0xf bank_mask:0xf
    v_mfma_f32_16x16x32_bf16 v[196:199], a[120:123], v[136:139], v[196:199]
    v_mul_f32_dpp v206, v27, v27 row_ror:4 row_mask:0xf bank_mask:0xf
    v_mul_f32_dpp v207, v31, v31 row_ror:4 row_mask:0xf bank_mask:0xf
    v_mfma_f32_16x16x32_bf16 v[196:199], a[116:119], v[132:135], v[196:199]
    v_cvt_pk_bf16_f32 v188, |v192|, |v193|
    v_cvt_pk_bf16_f32 v189, |v194|, |v195|
    v_mfma_f32_16x16x32_bf16 v[196:199], a[112:115], v[128:131], v[196:199]
    v_cvt_pk_bf16_f32 v158, v204, v205
    v_cvt_pk_bf16_f32 v159, v206, v207
    v_mfma_f32_16x16x32_bf16 v[192:195], a[0:3], v[144:147], v[96:99]
    v_mul_f32_dpp v204, v0, v0 row_ror:5 row_mask:0xf bank_mask:0xf
    v_mul_f32_dpp v205, v4, v4 row_ror:5 row_mask:0xf bank_mask:0xf
    v_mfma_f32_16x16x32_bf16 v[192:195], a[4:7], v[148:151], v[192:195]
    v_mul_f32_dpp v206, v1, v1 row_ror:5 row_mask:0xf bank_mask:0xf
    v_mul_f32_dpp v207, v5, v5 row_ror:5 row_mask:0xf bank_mask:0xf
    v_mfma_f32_16x16x32_bf16 v[192:195], a[8:11], v[152:155], v[192:195]
    v_cvt_pk_bf16_f32 v190, |v196|, |v197|
    v_cvt_pk_bf16_f32 v191, |v198|, |v199|
    v_mfma_f32_16x16x32_bf16 v[192:195], a[12:15], v[156:159], v[192:195]
    v_cvt_pk_bf16_f32 v128, v204, v205
    v_cvt_pk_bf16_f32 v129, v206, v207
    v_smfmac_f32_16x16x64_bf16 v[200:203], a[168:171], v[176:183], v242
    v_mul_f32_dpp v74, v10, v10 row_ror:8 row_mask:0xf bank_mask:0xf
    v_smfmac_f32_16x16x64_bf16 v[200:203], a[172:175], v[184:191], v242
    v_mul_f32_dpp v75, v11, v11 row_ror:8 row_mask:0xf bank_mask:0xf
    v_smfmac_f32_16x16x64_bf16 v[200:203], a[176:179], v[144:151], v242
    v_mul_f32_dpp v76, v12, v12 row_ror:8 row_mask:0xf bank_mask:0xf
    v_smfmac_f32_16x16x64_bf16 v[200:203], a[180:183], v[152:159], v242
    v_mul_f32_dpp v77, v13, v13 row_ror:8 row_mask:0xf bank_mask:0xf
    v_mfma_f32_16x16x32_bf16 v[196:199], a[28:31], v[156:159], v[100:103]
    v_mul_f32_dpp v204, v2, v2 row_ror:5 row_mask:0xf bank_mask:0xf
    v_mul_f32_dpp v205, v6, v6 row_ror:5 row_mask:0xf bank_mask:0xf
    v_mfma_f32_16x16x32_bf16 v[196:199], a[24:27], v[152:155], v[196:199]
    v_mul_f32_dpp v206, v3, v3 row_ror:5 row_mask:0xf bank_mask:0xf
    v_mul_f32_dpp v207, v7, v7 row_ror:5 row_mask:0xf bank_mask:0xf
    v_mfma_f32_16x16x32_bf16 v[196:199], a[20:23], v[148:151], v[196:199]
    v_cvt_pk_bf16_f32 v176, |v192|, |v193|
    v_cvt_pk_bf16_f32 v177, |v194|, |v195|
    v_mfma_f32_16x16x32_bf16 v[196:199], a[16:19], v[144:147], v[196:199]
    v_cvt_pk_bf16_f32 v130, v204, v205
    v_cvt_pk_bf16_f32 v131, v206, v207
    v_mfma_f32_16x16x32_bf16 v[192:195], a[32:35], v[144:147], v[104:107]
    v_mul_f32_dpp v204, v8, v8 row_ror:5 row_mask:0xf bank_mask:0xf
    v_mul_f32_dpp v205, v12, v12 row_ror:5 row_mask:0xf bank_mask:0xf
    v_mfma_f32_16x16x32_bf16 v[192:195], a[36:39], v[148:151], v[192:195]
    v_mul_f32_dpp v206, v9, v9 row_ror:5 row_mask:0xf bank_mask:0xf
    v_mul_f32_dpp v207, v13, v13 row_ror:5 row_mask:0xf bank_mask:0xf
    v_mfma_f32_16x16x32_bf16 v[192:195], a[40:43], v[152:155], v[192:195]
    v_cvt_pk_bf16_f32 v178, |v196|, |v197|
    v_cvt_pk_bf16_f32 v179, |v198|, |v199|
    v_mfma_f32_16x16x32_bf16 v[192:195], a[44:47], v[156:159], v[192:195]
    v_cvt_pk_bf16_f32 v132, v204, v205
    v_cvt_pk_bf16_f32 v133, v206, v207
    v_mfma_f32_16x16x32_bf16 v[196:199], a[60:63], v[156:159], v[108:111]
    v_mul_f32_dpp v204, v10, v10 row_ror:5 row_mask:0xf bank_mask:0xf
    v_mul_f32_dpp v205, v14, v14 row_ror:5 row_mask:0xf bank_mask:0xf
    v_mfma_f32_16x16x32_bf16 v[196:199], a[56:59], v[152:155], v[196:199]
    v_mul_f32_dpp v206, v11, v11 row_ror:5 row_mask:0xf bank_mask:0xf
    v_mul_f32_dpp v207, v15, v15 row_ror:5 row_mask:0xf bank_mask:0xf
    v_mfma_f32_16x16x32_bf16 v[196:199], a[52:55], v[148:151], v[196:199]
    v_cvt_pk_bf16_f32 v180, |v192|, |v193|
    v_cvt_pk_bf16_f32 v181, |v194|, |v195|
    v_mfma_f32_16x16x32_bf16 v[196:199], a[48:51], v[144:147], v[196:199]
    v_cvt_pk_bf16_f32 v134, v204, v205
    v_cvt_pk_bf16_f32 v135, v206, v207
    v_mfma_f32_16x16x32_bf16 v[192:195], a[64:67], v[144:147], v[112:115]
    v_mul_f32_dpp v204, v16, v16 row_ror:5 row_mask:0xf bank_mask:0xf
    v_mul_f32_dpp v205, v20, v20 row_ror:5 row_mask:0xf bank_mask:0xf
    v_mfma_f32_16x16x32_bf16 v[192:195], a[68:71], v[148:151], v[192:195]
    v_mul_f32_dpp v206, v17, v17 row_ror:5 row_mask:0xf bank_mask:0xf
    v_mul_f32_dpp v207, v21, v21 row_ror:5 row_mask:0xf bank_mask:0xf
    v_mfma_f32_16x16x32_bf16 v[192:195], a[72:75], v[152:155], v[192:195]
    v_cvt_pk_bf16_f32 v182, |v196|, |v197|
    v_cvt_pk_bf16_f32 v183, |v198|, |v199|
    v_mfma_f32_16x16x32_bf16 v[192:195], a[76:79], v[156:159], v[192:195]
    v_cvt_pk_bf16_f32 v136, v204, v205
    v_cvt_pk_bf16_f32 v137, v206, v207
    v_mfma_f32_16x16x32_bf16 v[196:199], a[92:95], v[156:159], v[116:119]
    v_mul_f32_dpp v204, v18, v18 row_ror:5 row_mask:0xf bank_mask:0xf
    v_mul_f32_dpp v205, v22, v22 row_ror:5 row_mask:0xf bank_mask:0xf
    v_mfma_f32_16x16x32_bf16 v[196:199], a[88:91], v[152:155], v[196:199]
    v_mul_f32_dpp v206, v19, v19 row_ror:5 row_mask:0xf bank_mask:0xf
    v_mul_f32_dpp v207, v23, v23 row_ror:5 row_mask:0xf bank_mask:0xf
    v_mfma_f32_16x16x32_bf16 v[196:199], a[84:87], v[148:151], v[196:199]
    v_cvt_pk_bf16_f32 v184, |v192|, |v193|
    v_cvt_pk_bf16_f32 v185, |v194|, |v195|
    v_mfma_f32_16x16x32_bf16 v[196:199], a[80:83], v[144:147], v[196:199]
    v_cvt_pk_bf16_f32 v138, v204, v205
    v_cvt_pk_bf16_f32 v139, v206, v207
    v_mfma_f32_16x16x32_bf16 v[192:195], a[96:99], v[144:147], v[120:123]
    v_mul_f32_dpp v204, v24, v24 row_ror:5 row_mask:0xf bank_mask:0xf
    v_mul_f32_dpp v205, v28, v28 row_ror:5 row_mask:0xf bank_mask:0xf
    v_mfma_f32_16x16x32_bf16 v[192:195], a[100:103], v[148:151], v[192:195]
    v_mul_f32_dpp v206, v25, v25 row_ror:5 row_mask:0xf bank_mask:0xf
    v_mul_f32_dpp v207, v29, v29 row_ror:5 row_mask:0xf bank_mask:0xf
    v_mfma_f32_16x16x32_bf16 v[192:195], a[104:107], v[152:155], v[192:195]
    v_cvt_pk_bf16_f32 v186, |v196|, |v197|
    v_cvt_pk_bf16_f32 v187, |v198|, |v199|
    v_mfma_f32_16x16x32_bf16 v[192:195], a[108:111], v[156:159], v[192:195]
    v_cvt_pk_bf16_f32 v140, v204, v205
    v_cvt_pk_bf16_f32 v141, v206, v207
    v_mfma_f32_16x16x32_bf16 v[196:199], a[124:127], v[156:159], v[124:127]
    v_mul_f32_dpp v204, v26, v26 row_ror:5 row_mask:0xf bank_mask:0xf
    v_mul_f32_dpp v205, v30, v30 row_ror:5 row_mask:0xf bank_mask:0xf
    v_mfma_f32_16x16x32_bf16 v[196:199], a[120:123], v[152:155], v[196:199]
    v_mul_f32_dpp v206, v27, v27 row_ror:5 row_mask:0xf bank_mask:0xf
    v_mul_f32_dpp v207, v31, v31 row_ror:5 row_mask:0xf bank_mask:0xf
    v_mfma_f32_16x16x32_bf16 v[196:199], a[116:119], v[148:151], v[196:199]
    v_cvt_pk_bf16_f32 v188, |v192|, |v193|
    v_cvt_pk_bf16_f32 v189, |v194|, |v195|
    v_mfma_f32_16x16x32_bf16 v[196:199], a[112:115], v[144:147], v[196:199]
    v_cvt_pk_bf16_f32 v142, v204, v205
    v_cvt_pk_bf16_f32 v143, v206, v207
    v_mfma_f32_16x16x32_bf16 v[192:195], a[0:3], v[128:131], v[96:99]
    v_mul_f32_dpp v204, v0, v0 row_ror:6 row_mask:0xf bank_mask:0xf
    v_mul_f32_dpp v205, v4, v4 row_ror:6 row_mask:0xf bank_mask:0xf
    v_mfma_f32_16x16x32_bf16 v[192:195], a[4:7], v[132:135], v[192:195]
    v_mul_f32_dpp v206, v1, v1 row_ror:6 row_mask:0xf bank_mask:0xf
    v_mul_f32_dpp v207, v5, v5 row_ror:6 row_mask:0xf bank_mask:0xf
    v_mfma_f32_16x16x32_bf16 v[192:195], a[8:11], v[136:139], v[192:195]
    v_cvt_pk_bf16_f32 v190, |v196|, |v197|
    v_cvt_pk_bf16_f32 v191, |v198|, |v199|
    v_mfma_f32_16x16x32_bf16 v[192:195], a[12:15], v[140:143], v[192:195]
    s_waitcnt vmcnt(4)
    v_cvt_pk_bf16_f32 v144, v204, v205
    v_cvt_pk_bf16_f32 v145, v206, v207
    v_smfmac_f32_16x16x64_bf16 v[200:203], a[184:187], v[176:183], v242
    v_lshlrev_b32 v32, 16, v36
    v_smfmac_f32_16x16x64_bf16 v[200:203], a[188:191], v[184:191], v242
    v_and_b32 v36, s41, v36
    v_mfma_f32_16x16x32_bf16 v[196:199], a[28:31], v[140:143], v[100:103]
    v_mul_f32_dpp v204, v2, v2 row_ror:6 row_mask:0xf bank_mask:0xf
    v_mul_f32_dpp v205, v6, v6 row_ror:6 row_mask:0xf bank_mask:0xf
    v_mfma_f32_16x16x32_bf16 v[196:199], a[24:27], v[136:139], v[196:199]
    v_mul_f32_dpp v206, v3, v3 row_ror:6 row_mask:0xf bank_mask:0xf
    v_mul_f32_dpp v207, v7, v7 row_ror:6 row_mask:0xf bank_mask:0xf
    v_mfma_f32_16x16x32_bf16 v[196:199], a[20:23], v[132:135], v[196:199]
    v_cvt_pk_bf16_f32 v176, |v192|, |v193|
    v_cvt_pk_bf16_f32 v177, |v194|, |v195|
    v_mfma_f32_16x16x32_bf16 v[196:199], a[16:19], v[128:131], v[196:199]
    v_add_f32 v212, v200, v201
    v_add_f32 v217, v202, v203
    v_mov_b64 v[200:201], 0
    v_mov_b64 v[202:203], 0
    v_cvt_pk_bf16_f32 v146, v204, v205
    v_cvt_pk_bf16_f32 v147, v206, v207
    v_smfmac_f32_16x16x64_bf16 v[200:203], a[128:131], v[128:135], v242
    v_lshlrev_b32 v33, 16, v37
    v_smfmac_f32_16x16x64_bf16 v[200:203], a[132:135], v[136:143], v242
    v_and_b32 v37, s41, v37
    v_mfma_f32_16x16x32_bf16 v[192:195], a[32:35], v[128:131], v[104:107]
    v_mul_f32_dpp v204, v8, v8 row_ror:6 row_mask:0xf bank_mask:0xf
    v_mul_f32_dpp v205, v12, v12 row_ror:6 row_mask:0xf bank_mask:0xf
    v_mfma_f32_16x16x32_bf16 v[192:195], a[36:39], v[132:135], v[192:195]
    v_mul_f32_dpp v206, v9, v9 row_ror:6 row_mask:0xf bank_mask:0xf
    v_mul_f32_dpp v207, v13, v13 row_ror:6 row_mask:0xf bank_mask:0xf
    v_mfma_f32_16x16x32_bf16 v[192:195], a[40:43], v[136:139], v[192:195]
    v_cvt_pk_bf16_f32 v178, |v196|, |v197|
    v_cvt_pk_bf16_f32 v179, |v198|, |v199|
    v_mfma_f32_16x16x32_bf16 v[192:195], a[44:47], v[140:143], v[192:195]
    v_cvt_pk_bf16_f32 v148, v204, v205
    v_cvt_pk_bf16_f32 v149, v206, v207
    v_mfma_f32_16x16x32_bf16 v[196:199], a[60:63], v[140:143], v[108:111]
    v_mul_f32_dpp v204, v10, v10 row_ror:6 row_mask:0xf bank_mask:0xf
    v_mul_f32_dpp v205, v14, v14 row_ror:6 row_mask:0xf bank_mask:0xf
    v_mfma_f32_16x16x32_bf16 v[196:199], a[56:59], v[136:139], v[196:199]
    v_mul_f32_dpp v206, v11, v11 row_ror:6 row_mask:0xf bank_mask:0xf
    v_mul_f32_dpp v207, v15, v15 row_ror:6 row_mask:0xf bank_mask:0xf
    v_mfma_f32_16x16x32_bf16 v[196:199], a[52:55], v[132:135], v[196:199]
    v_cvt_pk_bf16_f32 v180, |v192|, |v193|
    v_cvt_pk_bf16_f32 v181, |v194|, |v195|
    v_mfma_f32_16x16x32_bf16 v[196:199], a[48:51], v[128:131], v[196:199]
    v_cvt_pk_bf16_f32 v150, v204, v205
    v_cvt_pk_bf16_f32 v151, v206, v207
    v_lshlrev_b32 v34, 16, v38
    v_and_b32 v38, s41, v38
    v_lshlrev_b32 v35, 16, v39
    v_and_b32 v39, s41, v39
    v_mfma_f32_16x16x32_bf16 v[192:195], a[64:67], v[128:131], v[112:115]
    v_mul_f32_dpp v204, v16, v16 row_ror:6 row_mask:0xf bank_mask:0xf
    v_mul_f32_dpp v205, v20, v20 row_ror:6 row_mask:0xf bank_mask:0xf
    v_mfma_f32_16x16x32_bf16 v[192:195], a[68:71], v[132:135], v[192:195]
    v_mul_f32_dpp v206, v17, v17 row_ror:6 row_mask:0xf bank_mask:0xf
    v_mul_f32_dpp v207, v21, v21 row_ror:6 row_mask:0xf bank_mask:0xf
    v_mfma_f32_16x16x32_bf16 v[192:195], a[72:75], v[136:139], v[192:195]
    v_cvt_pk_bf16_f32 v182, |v196|, |v197|
    v_cvt_pk_bf16_f32 v183, |v198|, |v199|
    v_mfma_f32_16x16x32_bf16 v[192:195], a[76:79], v[140:143], v[192:195]
    s_waitcnt vmcnt(3)
    v_cvt_pk_bf16_f32 v152, v204, v205
    v_cvt_pk_bf16_f32 v153, v206, v207
    v_lshlrev_b32 v40, 16, v44
    v_and_b32 v44, s41, v44
    v_lshlrev_b32 v41, 16, v45
    v_and_b32 v45, s41, v45
    v_lshlrev_b32 v42, 16, v46
    v_and_b32 v46, s41, v46
    v_lshlrev_b32 v43, 16, v47
    v_and_b32 v47, s41, v47
    v_mfma_f32_16x16x32_bf16 v[196:199], a[92:95], v[140:143], v[116:119]
    v_mul_f32_dpp v204, v18, v18 row_ror:6 row_mask:0xf bank_mask:0xf
    v_mul_f32_dpp v205, v22, v22 row_ror:6 row_mask:0xf bank_mask:0xf
    v_mfma_f32_16x16x32_bf16 v[196:199], a[88:91], v[136:139], v[196:199]
    v_mul_f32_dpp v206, v19, v19 row_ror:6 row_mask:0xf bank_mask:0xf
    v_mul_f32_dpp v207, v23, v23 row_ror:6 row_mask:0xf bank_mask:0xf
    v_mfma_f32_16x16x32_bf16 v[196:199], a[84:87], v[132:135], v[196:199]
    v_cvt_pk_bf16_f32 v184, |v192|, |v193|
    v_cvt_pk_bf16_f32 v185, |v194|, |v195|
    v_mfma_f32_16x16x32_bf16 v[196:199], a[80:83], v[128:131], v[196:199]
    v_cvt_pk_bf16_f32 v154, v204, v205
    v_cvt_pk_bf16_f32 v155, v206, v207
    v_mfma_f32_16x16x32_bf16 v[192:195], a[96:99], v[128:131], v[120:123]
    v_mul_f32_dpp v204, v24, v24 row_ror:6 row_mask:0xf bank_mask:0xf
    v_mul_f32_dpp v205, v28, v28 row_ror:6 row_mask:0xf bank_mask:0xf
    v_mfma_f32_16x16x32_bf16 v[192:195], a[100:103], v[132:135], v[192:195]
    v_mul_f32_dpp v206, v25, v25 row_ror:6 row_mask:0xf bank_mask:0xf
    v_mul_f32_dpp v207, v29, v29 row_ror:6 row_mask:0xf bank_mask:0xf
    v_mfma_f32_16x16x32_bf16 v[192:195], a[104:107], v[136:139], v[192:195]
    v_cvt_pk_bf16_f32 v186, |v196|, |v197|
    v_cvt_pk_bf16_f32 v187, |v198|, |v199|
    v_mfma_f32_16x16x32_bf16 v[192:195], a[108:111], v[140:143], v[192:195]
    v_cvt_pk_bf16_f32 v156, v204, v205
    v_cvt_pk_bf16_f32 v157, v206, v207
    v_mfma_f32_16x16x32_bf16 v[196:199], a[124:127], v[140:143], v[124:127]
    v_mul_f32_dpp v204, v26, v26 row_ror:6 row_mask:0xf bank_mask:0xf
    v_mul_f32_dpp v205, v30, v30 row_ror:6 row_mask:0xf bank_mask:0xf
    v_mfma_f32_16x16x32_bf16 v[196:199], a[120:123], v[136:139], v[196:199]
    v_mul_f32_dpp v206, v27, v27 row_ror:6 row_mask:0xf bank_mask:0xf
    v_mul_f32_dpp v207, v31, v31 row_ror:6 row_mask:0xf bank_mask:0xf
    v_mfma_f32_16x16x32_bf16 v[196:199], a[116:119], v[132:135], v[196:199]
    v_cvt_pk_bf16_f32 v188, |v192|, |v193|
    v_cvt_pk_bf16_f32 v189, |v194|, |v195|
    v_mfma_f32_16x16x32_bf16 v[196:199], a[112:115], v[128:131], v[196:199]
    v_cvt_pk_bf16_f32 v158, v204, v205
    v_cvt_pk_bf16_f32 v159, v206, v207
    v_mfma_f32_16x16x32_bf16 v[192:195], a[0:3], v[144:147], v[96:99]
    v_mul_f32_dpp v204, v0, v0 row_ror:7 row_mask:0xf bank_mask:0xf
    v_mul_f32_dpp v205, v4, v4 row_ror:7 row_mask:0xf bank_mask:0xf
    v_mfma_f32_16x16x32_bf16 v[192:195], a[4:7], v[148:151], v[192:195]
    v_mul_f32_dpp v206, v1, v1 row_ror:7 row_mask:0xf bank_mask:0xf
    v_mul_f32_dpp v207, v5, v5 row_ror:7 row_mask:0xf bank_mask:0xf
    v_mfma_f32_16x16x32_bf16 v[192:195], a[8:11], v[152:155], v[192:195]
    v_cvt_pk_bf16_f32 v190, |v196|, |v197|
    v_cvt_pk_bf16_f32 v191, |v198|, |v199|
    v_mfma_f32_16x16x32_bf16 v[192:195], a[12:15], v[156:159], v[192:195]
    s_waitcnt vmcnt(1)
    v_cvt_pk_bf16_f32 v128, v204, v205
    v_cvt_pk_bf16_f32 v129, v206, v207
    v_smfmac_f32_16x16x64_bf16 v[200:203], a[136:139], v[176:183], v242
    v_lshlrev_b32 v48, 16, v52
    v_smfmac_f32_16x16x64_bf16 v[200:203], a[140:143], v[184:191], v242
    v_and_b32 v52, s41, v52
    v_smfmac_f32_16x16x64_bf16 v[200:203], a[144:147], v[144:151], v242
    v_lshlrev_b32 v49, 16, v53
    v_smfmac_f32_16x16x64_bf16 v[200:203], a[148:151], v[152:159], v242
    v_and_b32 v53, s41, v53
    v_mfma_f32_16x16x32_bf16 v[196:199], a[28:31], v[156:159], v[100:103]
    v_mul_f32_dpp v204, v2, v2 row_ror:7 row_mask:0xf bank_mask:0xf
    v_mul_f32_dpp v205, v6, v6 row_ror:7 row_mask:0xf bank_mask:0xf
    v_mfma_f32_16x16x32_bf16 v[196:199], a[24:27], v[152:155], v[196:199]
    v_mul_f32_dpp v206, v3, v3 row_ror:7 row_mask:0xf bank_mask:0xf
    v_mul_f32_dpp v207, v7, v7 row_ror:7 row_mask:0xf bank_mask:0xf
    v_mfma_f32_16x16x32_bf16 v[196:199], a[20:23], v[148:151], v[196:199]
    v_cvt_pk_bf16_f32 v176, |v192|, |v193|
    v_cvt_pk_bf16_f32 v177, |v194|, |v195|
    v_mfma_f32_16x16x32_bf16 v[196:199], a[16:19], v[144:147], v[196:199]
    v_cvt_pk_bf16_f32 v130, v204, v205
    v_cvt_pk_bf16_f32 v131, v206, v207
    v_mfma_f32_16x16x32_bf16 v[192:195], a[32:35], v[144:147], v[104:107]
    v_mul_f32_dpp v204, v8, v8 row_ror:7 row_mask:0xf bank_mask:0xf
    v_mul_f32_dpp v205, v12, v12 row_ror:7 row_mask:0xf bank_mask:0xf
    v_mfma_f32_16x16x32_bf16 v[192:195], a[36:39], v[148:151], v[192:195]
    v_mul_f32_dpp v206, v9, v9 row_ror:7 row_mask:0xf bank_mask:0xf
    v_mul_f32_dpp v207, v13, v13 row_ror:7 row_mask:0xf bank_mask:0xf
    v_mfma_f32_16x16x32_bf16 v[192:195], a[40:43], v[152:155], v[192:195]
    v_cvt_pk_bf16_f32 v178, |v196|, |v197|
    v_cvt_pk_bf16_f32 v179, |v198|, |v199|
    v_mfma_f32_16x16x32_bf16 v[192:195], a[44:47], v[156:159], v[192:195]
    v_cvt_pk_bf16_f32 v132, v204, v205
    v_cvt_pk_bf16_f32 v133, v206, v207
    v_mfma_f32_16x16x32_bf16 v[196:199], a[60:63], v[156:159], v[108:111]
    v_mul_f32_dpp v204, v10, v10 row_ror:7 row_mask:0xf bank_mask:0xf
    v_mul_f32_dpp v205, v14, v14 row_ror:7 row_mask:0xf bank_mask:0xf
    v_mfma_f32_16x16x32_bf16 v[196:199], a[56:59], v[152:155], v[196:199]
    v_mul_f32_dpp v206, v11, v11 row_ror:7 row_mask:0xf bank_mask:0xf
    v_mul_f32_dpp v207, v15, v15 row_ror:7 row_mask:0xf bank_mask:0xf
    v_mfma_f32_16x16x32_bf16 v[196:199], a[52:55], v[148:151], v[196:199]
    v_cvt_pk_bf16_f32 v180, |v192|, |v193|
    v_cvt_pk_bf16_f32 v181, |v194|, |v195|
    v_mfma_f32_16x16x32_bf16 v[196:199], a[48:51], v[144:147], v[196:199]
    v_cvt_pk_bf16_f32 v134, v204, v205
    v_cvt_pk_bf16_f32 v135, v206, v207
    v_lshlrev_b32 v50, 16, v54
    v_and_b32 v54, s41, v54
    v_lshlrev_b32 v51, 16, v55
    v_and_b32 v55, s41, v55
    v_lshlrev_b32 v56, 16, v60
    v_and_b32 v60, s41, v60
    v_lshlrev_b32 v57, 16, v61
    v_and_b32 v61, s41, v61
    v_mfma_f32_16x16x32_bf16 v[192:195], a[64:67], v[144:147], v[112:115]
    v_mul_f32_dpp v204, v16, v16 row_ror:7 row_mask:0xf bank_mask:0xf
    v_mul_f32_dpp v205, v20, v20 row_ror:7 row_mask:0xf bank_mask:0xf
    v_mfma_f32_16x16x32_bf16 v[192:195], a[68:71], v[148:151], v[192:195]
    v_mul_f32_dpp v206, v17, v17 row_ror:7 row_mask:0xf bank_mask:0xf
    v_mul_f32_dpp v207, v21, v21 row_ror:7 row_mask:0xf bank_mask:0xf
    v_mfma_f32_16x16x32_bf16 v[192:195], a[72:75], v[152:155], v[192:195]
    v_cvt_pk_bf16_f32 v182, |v196|, |v197|
    v_cvt_pk_bf16_f32 v183, |v198|, |v199|
    v_mfma_f32_16x16x32_bf16 v[192:195], a[76:79], v[156:159], v[192:195]
    v_cvt_pk_bf16_f32 v136, v204, v205
    v_cvt_pk_bf16_f32 v137, v206, v207
    v_mfma_f32_16x16x32_bf16 v[196:199], a[92:95], v[156:159], v[116:119]
    v_mul_f32_dpp v204, v18, v18 row_ror:7 row_mask:0xf bank_mask:0xf
    v_mul_f32_dpp v205, v22, v22 row_ror:7 row_mask:0xf bank_mask:0xf
    v_mfma_f32_16x16x32_bf16 v[196:199], a[88:91], v[152:155], v[196:199]
    v_mul_f32_dpp v206, v19, v19 row_ror:7 row_mask:0xf bank_mask:0xf
    v_mul_f32_dpp v207, v23, v23 row_ror:7 row_mask:0xf bank_mask:0xf
    v_mfma_f32_16x16x32_bf16 v[196:199], a[84:87], v[148:151], v[196:199]
    v_cvt_pk_bf16_f32 v184, |v192|, |v193|
    v_cvt_pk_bf16_f32 v185, |v194|, |v195|
    v_mfma_f32_16x16x32_bf16 v[196:199], a[80:83], v[144:147], v[196:199]
    v_cvt_pk_bf16_f32 v138, v204, v205
    v_cvt_pk_bf16_f32 v139, v206, v207
    v_mfma_f32_16x16x32_bf16 v[192:195], a[96:99], v[144:147], v[120:123]
    v_mul_f32_dpp v204, v24, v24 row_ror:7 row_mask:0xf bank_mask:0xf
    v_mul_f32_dpp v205, v28, v28 row_ror:7 row_mask:0xf bank_mask:0xf
    v_mfma_f32_16x16x32_bf16 v[192:195], a[100:103], v[148:151], v[192:195]
    v_mul_f32_dpp v206, v25, v25 row_ror:7 row_mask:0xf bank_mask:0xf
    v_mul_f32_dpp v207, v29, v29 row_ror:7 row_mask:0xf bank_mask:0xf
    v_mfma_f32_16x16x32_bf16 v[192:195], a[104:107], v[152:155], v[192:195]
    v_cvt_pk_bf16_f32 v186, |v196|, |v197|
    v_cvt_pk_bf16_f32 v187, |v198|, |v199|
    v_mfma_f32_16x16x32_bf16 v[192:195], a[108:111], v[156:159], v[192:195]
    v_cvt_pk_bf16_f32 v140, v204, v205
    v_cvt_pk_bf16_f32 v141, v206, v207
    v_mfma_f32_16x16x32_bf16 v[196:199], a[124:127], v[156:159], v[124:127]
    v_mul_f32_dpp v204, v26, v26 row_ror:7 row_mask:0xf bank_mask:0xf
    v_mul_f32_dpp v205, v30, v30 row_ror:7 row_mask:0xf bank_mask:0xf
    v_mfma_f32_16x16x32_bf16 v[196:199], a[120:123], v[152:155], v[196:199]
    v_mul_f32_dpp v206, v27, v27 row_ror:7 row_mask:0xf bank_mask:0xf
    v_mul_f32_dpp v207, v31, v31 row_ror:7 row_mask:0xf bank_mask:0xf
    v_mfma_f32_16x16x32_bf16 v[196:199], a[116:119], v[148:151], v[196:199]
    v_cvt_pk_bf16_f32 v188, |v192|, |v193|
    v_cvt_pk_bf16_f32 v189, |v194|, |v195|
    v_mfma_f32_16x16x32_bf16 v[196:199], a[112:115], v[144:147], v[196:199]
    v_cvt_pk_bf16_f32 v142, v204, v205
    v_cvt_pk_bf16_f32 v143, v206, v207
    v_mfma_f32_16x16x32_bf16 v[192:195], a[0:3], v[128:131], v[96:99]
    v_mul_f32_dpp v204, v32, v0 row_newbcast:15 row_mask:0xf bank_mask:0xf
    v_mul_f32_dpp v205, v36, v4 row_newbcast:15 row_mask:0xf bank_mask:0xf
    v_mfma_f32_16x16x32_bf16 v[192:195], a[4:7], v[132:135], v[192:195]
    v_mul_f32_dpp v206, v33, v1 row_newbcast:15 row_mask:0xf bank_mask:0xf
    v_mul_f32_dpp v207, v37, v5 row_newbcast:15 row_mask:0xf bank_mask:0xf
    v_mfma_f32_16x16x32_bf16 v[192:195], a[8:11], v[136:139], v[192:195]
    v_cvt_pk_bf16_f32 v190, |v196|, |v197|
    v_cvt_pk_bf16_f32 v191, |v198|, |v199|
    v_mfma_f32_16x16x32_bf16 v[192:195], a[12:15], v[140:143], v[192:195]
    v_cvt_pk_bf16_f32 v144, v204, v205
    v_cvt_pk_bf16_f32 v145, v206, v207
    v_smfmac_f32_16x16x64_bf16 v[200:203], a[152:155], v[176:183], v242
    v_lshlrev_b32 v58, 16, v62
    v_smfmac_f32_16x16x64_bf16 v[200:203], a[156:159], v[184:191], v242
    v_and_b32 v62, s41, v62
    v_smfmac_f32_16x16x64_bf16 v[200:203], a[160:163], v[128:135], v242
    v_lshlrev_b32 v59, 16, v63
    v_smfmac_f32_16x16x64_bf16 v[200:203], a[164:167], v[136:143], v242
    v_and_b32 v63, s41, v63
    v_mfma_f32_16x16x32_bf16 v[196:199], a[28:31], v[140:143], v[100:103]
    v_mul_f32_dpp v204, v34, v2 row_newbcast:15 row_mask:0xf bank_mask:0xf
    v_mul_f32_dpp v205, v38, v6 row_newbcast:15 row_mask:0xf bank_mask:0xf
    v_mfma_f32_16x16x32_bf16 v[196:199], a[24:27], v[136:139], v[196:199]
    v_mul_f32_dpp v206, v35, v3 row_newbcast:15 row_mask:0xf bank_mask:0xf
    v_mul_f32_dpp v207, v39, v7 row_newbcast:15 row_mask:0xf bank_mask:0xf
    v_mfma_f32_16x16x32_bf16 v[196:199], a[20:23], v[132:135], v[196:199]
    v_cvt_pk_bf16_f32 v176, |v192|, |v193|
    v_cvt_pk_bf16_f32 v177, |v194|, |v195|
    v_mfma_f32_16x16x32_bf16 v[196:199], a[16:19], v[128:131], v[196:199]
    v_cvt_pk_bf16_f32 v146, v204, v205
    v_cvt_pk_bf16_f32 v147, v206, v207
    v_mfma_f32_16x16x32_bf16 v[192:195], a[32:35], v[128:131], v[104:107]
    v_mul_f32_dpp v204, v40, v8 row_newbcast:15 row_mask:0xf bank_mask:0xf
    v_mul_f32_dpp v205, v44, v12 row_newbcast:15 row_mask:0xf bank_mask:0xf
    v_mfma_f32_16x16x32_bf16 v[192:195], a[36:39], v[132:135], v[192:195]
    v_mul_f32_dpp v206, v41, v9 row_newbcast:15 row_mask:0xf bank_mask:0xf
    v_mul_f32_dpp v207, v45, v13 row_newbcast:15 row_mask:0xf bank_mask:0xf
    v_mfma_f32_16x16x32_bf16 v[192:195], a[40:43], v[136:139], v[192:195]
    v_cvt_pk_bf16_f32 v178, |v196|, |v197|
    v_cvt_pk_bf16_f32 v179, |v198|, |v199|
    v_mfma_f32_16x16x32_bf16 v[192:195], a[44:47], v[140:143], v[192:195]
    v_cvt_pk_bf16_f32 v148, v204, v205
    v_cvt_pk_bf16_f32 v149, v206, v207
    v_mfma_f32_16x16x32_bf16 v[196:199], a[60:63], v[140:143], v[108:111]
    v_mul_f32_dpp v204, v42, v10 row_newbcast:15 row_mask:0xf bank_mask:0xf
    v_mul_f32_dpp v205, v46, v14 row_newbcast:15 row_mask:0xf bank_mask:0xf
    v_mfma_f32_16x16x32_bf16 v[196:199], a[56:59], v[136:139], v[196:199]
    v_mul_f32_dpp v206, v43, v11 row_newbcast:15 row_mask:0xf bank_mask:0xf
    v_mul_f32_dpp v207, v47, v15 row_newbcast:15 row_mask:0xf bank_mask:0xf
    v_mfma_f32_16x16x32_bf16 v[196:199], a[52:55], v[132:135], v[196:199]
    v_cvt_pk_bf16_f32 v180, |v192|, |v193|
    v_cvt_pk_bf16_f32 v181, |v194|, |v195|
    v_mfma_f32_16x16x32_bf16 v[196:199], a[48:51], v[128:131], v[196:199]
    v_cvt_pk_bf16_f32 v150, v204, v205
    v_cvt_pk_bf16_f32 v151, v206, v207
    v_mfma_f32_16x16x32_bf16 v[192:195], a[64:67], v[128:131], v[112:115]
    v_mul_f32_dpp v204, v48, v16 row_newbcast:15 row_mask:0xf bank_mask:0xf
    v_mul_f32_dpp v205, v52, v20 row_newbcast:15 row_mask:0xf bank_mask:0xf
    v_mfma_f32_16x16x32_bf16 v[192:195], a[68:71], v[132:135], v[192:195]
    v_mul_f32_dpp v206, v49, v17 row_newbcast:15 row_mask:0xf bank_mask:0xf
    v_mul_f32_dpp v207, v53, v21 row_newbcast:15 row_mask:0xf bank_mask:0xf
    v_mfma_f32_16x16x32_bf16 v[192:195], a[72:75], v[136:139], v[192:195]
    v_cvt_pk_bf16_f32 v182, |v196|, |v197|
    v_cvt_pk_bf16_f32 v183, |v198|, |v199|
    v_mfma_f32_16x16x32_bf16 v[192:195], a[76:79], v[140:143], v[192:195]
    s_waitcnt vmcnt(0)
    v_lshl_add_u32 v239, v239, 8, v246
    v_cvt_pk_bf16_f32 v152, v204, v205
    v_cvt_pk_bf16_f32 v153, v206, v207
    v_mfma_f32_16x16x32_bf16 v[196:199], a[92:95], v[140:143], v[116:119]
    v_mul_f32_dpp v204, v50, v18 row_newbcast:15 row_mask:0xf bank_mask:0xf
    v_mul_f32_dpp v205, v54, v22 row_newbcast:15 row_mask:0xf bank_mask:0xf
    v_mfma_f32_16x16x32_bf16 v[196:199], a[88:91], v[136:139], v[196:199]
    v_mul_f32_dpp v206, v51, v19 row_newbcast:15 row_mask:0xf bank_mask:0xf
    v_mul_f32_dpp v207, v55, v23 row_newbcast:15 row_mask:0xf bank_mask:0xf
    v_mfma_f32_16x16x32_bf16 v[196:199], a[84:87], v[132:135], v[196:199]
    v_cvt_pk_bf16_f32 v184, |v192|, |v193|
    v_cvt_pk_bf16_f32 v185, |v194|, |v195|
    v_mfma_f32_16x16x32_bf16 v[196:199], a[80:83], v[128:131], v[196:199]
    v_cvt_pk_bf16_f32 v154, v204, v205
    v_cvt_pk_bf16_f32 v155, v206, v207
    v_mfma_f32_16x16x32_bf16 v[192:195], a[96:99], v[128:131], v[120:123]
    v_mul_f32_dpp v204, v56, v24 row_newbcast:15 row_mask:0xf bank_mask:0xf
    v_mul_f32_dpp v205, v60, v28 row_newbcast:15 row_mask:0xf bank_mask:0xf
    v_mfma_f32_16x16x32_bf16 v[192:195], a[100:103], v[132:135], v[192:195]
    v_mul_f32_dpp v206, v57, v25 row_newbcast:15 row_mask:0xf bank_mask:0xf
    v_mul_f32_dpp v207, v61, v29 row_newbcast:15 row_mask:0xf bank_mask:0xf
    v_mfma_f32_16x16x32_bf16 v[192:195], a[104:107], v[136:139], v[192:195]
    v_cvt_pk_bf16_f32 v186, |v196|, |v197|
    v_cvt_pk_bf16_f32 v187, |v198|, |v199|
    v_mfma_f32_16x16x32_bf16 v[192:195], a[108:111], v[140:143], v[192:195]
    v_cvt_pk_bf16_f32 v156, v204, v205
    v_cvt_pk_bf16_f32 v157, v206, v207
    v_mfma_f32_16x16x32_bf16 v[196:199], a[124:127], v[140:143], v[124:127]
    v_mul_f32_dpp v204, v58, v26 row_newbcast:15 row_mask:0xf bank_mask:0xf
    v_mul_f32_dpp v205, v62, v30 row_newbcast:15 row_mask:0xf bank_mask:0xf
    v_mfma_f32_16x16x32_bf16 v[196:199], a[120:123], v[136:139], v[196:199]
    v_mul_f32_dpp v206, v59, v27 row_newbcast:15 row_mask:0xf bank_mask:0xf
    v_mul_f32_dpp v207, v63, v31 row_newbcast:15 row_mask:0xf bank_mask:0xf
    v_mfma_f32_16x16x32_bf16 v[196:199], a[116:119], v[132:135], v[196:199]
    v_cvt_pk_bf16_f32 v188, |v192|, |v193|
    v_cvt_pk_bf16_f32 v189, |v194|, |v195|
    v_mfma_f32_16x16x32_bf16 v[196:199], a[112:115], v[128:131], v[196:199]
    v_cvt_pk_bf16_f32 v158, v204, v205
    v_cvt_pk_bf16_f32 v159, v206, v207
    v_mfma_f32_16x16x32_bf16 v[192:195], a[0:3], v[144:147], v[96:99]
    v_mul_f32_dpp v204, v32, v0 row_newbcast:1 row_mask:0xf bank_mask:0xf
    v_mul_f32_dpp v205, v36, v4 row_newbcast:1 row_mask:0xf bank_mask:0xf
    v_mfma_f32_16x16x32_bf16 v[192:195], a[4:7], v[148:151], v[192:195]
    v_mul_f32_dpp v206, v33, v1 row_newbcast:1 row_mask:0xf bank_mask:0xf
    v_mul_f32_dpp v207, v37, v5 row_newbcast:1 row_mask:0xf bank_mask:0xf
    v_mfma_f32_16x16x32_bf16 v[192:195], a[8:11], v[152:155], v[192:195]
    v_cvt_pk_bf16_f32 v190, |v196|, |v197|
    v_cvt_pk_bf16_f32 v191, |v198|, |v199|
    v_mfma_f32_16x16x32_bf16 v[192:195], a[12:15], v[156:159], v[192:195]
    v_cvt_pk_bf16_f32 v128, v204, v205
    v_cvt_pk_bf16_f32 v129, v206, v207
    v_smfmac_f32_16x16x64_bf16 v[200:203], a[168:171], v[176:183], v242
    v_mul_f32_dpp v78, v14, v14 row_ror:8 row_mask:0xf bank_mask:0xf
    v_smfmac_f32_16x16x64_bf16 v[200:203], a[172:175], v[184:191], v242
    v_mul_f32_dpp v79, v15, v15 row_ror:8 row_mask:0xf bank_mask:0xf
    v_smfmac_f32_16x16x64_bf16 v[200:203], a[176:179], v[144:151], v242
    v_mul_f32_dpp v80, v16, v16 row_ror:8 row_mask:0xf bank_mask:0xf
    v_smfmac_f32_16x16x64_bf16 v[200:203], a[180:183], v[152:159], v242
    v_mul_f32_dpp v81, v17, v17 row_ror:8 row_mask:0xf bank_mask:0xf
    v_mfma_f32_16x16x32_bf16 v[196:199], a[28:31], v[156:159], v[100:103]
    v_mul_f32_dpp v204, v34, v2 row_newbcast:1 row_mask:0xf bank_mask:0xf
    v_mul_f32_dpp v205, v38, v6 row_newbcast:1 row_mask:0xf bank_mask:0xf
    v_mfma_f32_16x16x32_bf16 v[196:199], a[24:27], v[152:155], v[196:199]
    v_mul_f32_dpp v206, v35, v3 row_newbcast:1 row_mask:0xf bank_mask:0xf
    v_mul_f32_dpp v207, v39, v7 row_newbcast:1 row_mask:0xf bank_mask:0xf
    v_mfma_f32_16x16x32_bf16 v[196:199], a[20:23], v[148:151], v[196:199]
    v_cvt_pk_bf16_f32 v176, |v192|, |v193|
    v_cvt_pk_bf16_f32 v177, |v194|, |v195|
    v_mfma_f32_16x16x32_bf16 v[196:199], a[16:19], v[144:147], v[196:199]
    v_cvt_pk_bf16_f32 v130, v204, v205
    v_cvt_pk_bf16_f32 v131, v206, v207
    v_mfma_f32_16x16x32_bf16 v[192:195], a[32:35], v[144:147], v[104:107]
    v_mul_f32_dpp v204, v40, v8 row_newbcast:1 row_mask:0xf bank_mask:0xf
    v_mul_f32_dpp v205, v44, v12 row_newbcast:1 row_mask:0xf bank_mask:0xf
    v_mfma_f32_16x16x32_bf16 v[192:195], a[36:39], v[148:151], v[192:195]
    v_mul_f32_dpp v206, v41, v9 row_newbcast:1 row_mask:0xf bank_mask:0xf
    v_mul_f32_dpp v207, v45, v13 row_newbcast:1 row_mask:0xf bank_mask:0xf
    v_mfma_f32_16x16x32_bf16 v[192:195], a[40:43], v[152:155], v[192:195]
    v_cvt_pk_bf16_f32 v178, |v196|, |v197|
    v_cvt_pk_bf16_f32 v179, |v198|, |v199|
    v_mfma_f32_16x16x32_bf16 v[192:195], a[44:47], v[156:159], v[192:195]
    v_cvt_pk_bf16_f32 v132, v204, v205
    v_cvt_pk_bf16_f32 v133, v206, v207
    v_mfma_f32_16x16x32_bf16 v[196:199], a[60:63], v[156:159], v[108:111]
    v_mul_f32_dpp v204, v42, v10 row_newbcast:1 row_mask:0xf bank_mask:0xf
    v_mul_f32_dpp v205, v46, v14 row_newbcast:1 row_mask:0xf bank_mask:0xf
    v_mfma_f32_16x16x32_bf16 v[196:199], a[56:59], v[152:155], v[196:199]
    v_mul_f32_dpp v206, v43, v11 row_newbcast:1 row_mask:0xf bank_mask:0xf
    v_mul_f32_dpp v207, v47, v15 row_newbcast:1 row_mask:0xf bank_mask:0xf
    v_mfma_f32_16x16x32_bf16 v[196:199], a[52:55], v[148:151], v[196:199]
    v_cvt_pk_bf16_f32 v180, |v192|, |v193|
    v_cvt_pk_bf16_f32 v181, |v194|, |v195|
    v_mfma_f32_16x16x32_bf16 v[196:199], a[48:51], v[144:147], v[196:199]
    v_cvt_pk_bf16_f32 v134, v204, v205
    v_cvt_pk_bf16_f32 v135, v206, v207
    v_mfma_f32_16x16x32_bf16 v[192:195], a[64:67], v[144:147], v[112:115]
    v_mul_f32_dpp v204, v48, v16 row_newbcast:1 row_mask:0xf bank_mask:0xf
    v_mul_f32_dpp v205, v52, v20 row_newbcast:1 row_mask:0xf bank_mask:0xf
    v_mfma_f32_16x16x32_bf16 v[192:195], a[68:71], v[148:151], v[192:195]
    v_mul_f32_dpp v206, v49, v17 row_newbcast:1 row_mask:0xf bank_mask:0xf
    v_mul_f32_dpp v207, v53, v21 row_newbcast:1 row_mask:0xf bank_mask:0xf
    v_mfma_f32_16x16x32_bf16 v[192:195], a[72:75], v[152:155], v[192:195]
    v_cvt_pk_bf16_f32 v182, |v196|, |v197|
    v_cvt_pk_bf16_f32 v183, |v198|, |v199|
    v_mfma_f32_16x16x32_bf16 v[192:195], a[76:79], v[156:159], v[192:195]
    s_waitcnt vmcnt(5)
    v_lshl_add_u32 v238, v238, 8, v246
    v_cvt_pk_bf16_f32 v136, v204, v205
    v_cvt_pk_bf16_f32 v137, v206, v207
    v_mfma_f32_16x16x32_bf16 v[196:199], a[92:95], v[156:159], v[116:119]
    v_mul_f32_dpp v204, v50, v18 row_newbcast:1 row_mask:0xf bank_mask:0xf
    v_mul_f32_dpp v205, v54, v22 row_newbcast:1 row_mask:0xf bank_mask:0xf
    v_mfma_f32_16x16x32_bf16 v[196:199], a[88:91], v[152:155], v[196:199]
    v_mul_f32_dpp v206, v51, v19 row_newbcast:1 row_mask:0xf bank_mask:0xf
    v_mul_f32_dpp v207, v55, v23 row_newbcast:1 row_mask:0xf bank_mask:0xf
    v_mfma_f32_16x16x32_bf16 v[196:199], a[84:87], v[148:151], v[196:199]
    v_cvt_pk_bf16_f32 v184, |v192|, |v193|
    v_cvt_pk_bf16_f32 v185, |v194|, |v195|
    v_mfma_f32_16x16x32_bf16 v[196:199], a[80:83], v[144:147], v[196:199]
    buffer_load_dword v241, v238, s[24:27], 0 offen
    v_cvt_pk_bf16_f32 v138, v204, v205
    v_cvt_pk_bf16_f32 v139, v206, v207
    v_mfma_f32_16x16x32_bf16 v[192:195], a[96:99], v[144:147], v[120:123]
    v_mul_f32_dpp v204, v56, v24 row_newbcast:1 row_mask:0xf bank_mask:0xf
    v_mul_f32_dpp v205, v60, v28 row_newbcast:1 row_mask:0xf bank_mask:0xf
    v_mfma_f32_16x16x32_bf16 v[192:195], a[100:103], v[148:151], v[192:195]
    v_mul_f32_dpp v206, v57, v25 row_newbcast:1 row_mask:0xf bank_mask:0xf
    v_mul_f32_dpp v207, v61, v29 row_newbcast:1 row_mask:0xf bank_mask:0xf
    v_mfma_f32_16x16x32_bf16 v[192:195], a[104:107], v[152:155], v[192:195]
    v_cvt_pk_bf16_f32 v186, |v196|, |v197|
    v_cvt_pk_bf16_f32 v187, |v198|, |v199|
    v_mfma_f32_16x16x32_bf16 v[192:195], a[108:111], v[156:159], v[192:195]
    v_cvt_pk_bf16_f32 v140, v204, v205
    v_cvt_pk_bf16_f32 v141, v206, v207
    v_mfma_f32_16x16x32_bf16 v[196:199], a[124:127], v[156:159], v[124:127]
    v_mul_f32_dpp v204, v58, v26 row_newbcast:1 row_mask:0xf bank_mask:0xf
    v_mul_f32_dpp v205, v62, v30 row_newbcast:1 row_mask:0xf bank_mask:0xf
    v_mfma_f32_16x16x32_bf16 v[196:199], a[120:123], v[152:155], v[196:199]
    v_mul_f32_dpp v206, v59, v27 row_newbcast:1 row_mask:0xf bank_mask:0xf
    v_mul_f32_dpp v207, v63, v31 row_newbcast:1 row_mask:0xf bank_mask:0xf
    v_mfma_f32_16x16x32_bf16 v[196:199], a[116:119], v[148:151], v[196:199]
    v_cvt_pk_bf16_f32 v188, |v192|, |v193|
    v_cvt_pk_bf16_f32 v189, |v194|, |v195|
    v_mfma_f32_16x16x32_bf16 v[196:199], a[112:115], v[144:147], v[196:199]
    v_cvt_pk_bf16_f32 v142, v204, v205
    v_cvt_pk_bf16_f32 v143, v206, v207
    v_mfma_f32_16x16x32_bf16 v[192:195], a[0:3], v[128:131], v[96:99]
    v_mul_f32_dpp v204, v32, v0 row_newbcast:4 row_mask:0xf bank_mask:0xf
    v_mul_f32_dpp v205, v36, v4 row_newbcast:4 row_mask:0xf bank_mask:0xf
    v_mfma_f32_16x16x32_bf16 v[192:195], a[4:7], v[132:135], v[192:195]
    v_mul_f32_dpp v206, v33, v1 row_newbcast:4 row_mask:0xf bank_mask:0xf
    v_mul_f32_dpp v207, v37, v5 row_newbcast:4 row_mask:0xf bank_mask:0xf
    v_mfma_f32_16x16x32_bf16 v[192:195], a[8:11], v[136:139], v[192:195]
    v_cvt_pk_bf16_f32 v190, |v196|, |v197|
    v_cvt_pk_bf16_f32 v191, |v198|, |v199|
    v_mfma_f32_16x16x32_bf16 v[192:195], a[12:15], v[140:143], v[192:195]
    v_cvt_pk_bf16_f32 v144, v204, v205
    v_cvt_pk_bf16_f32 v145, v206, v207
    v_smfmac_f32_16x16x64_bf16 v[200:203], a[184:187], v[176:183], v242
    v_mul_f32_dpp v82, v18, v18 row_ror:8 row_mask:0xf bank_mask:0xf
    v_smfmac_f32_16x16x64_bf16 v[200:203], a[188:191], v[184:191], v242
    v_mul_f32_dpp v83, v19, v19 row_ror:8 row_mask:0xf bank_mask:0xf
    v_mfma_f32_16x16x32_bf16 v[196:199], a[28:31], v[140:143], v[100:103]
    v_mul_f32_dpp v204, v34, v2 row_newbcast:4 row_mask:0xf bank_mask:0xf
    v_mul_f32_dpp v205, v38, v6 row_newbcast:4 row_mask:0xf bank_mask:0xf
    v_mfma_f32_16x16x32_bf16 v[196:199], a[24:27], v[136:139], v[196:199]
    v_mul_f32_dpp v206, v35, v3 row_newbcast:4 row_mask:0xf bank_mask:0xf
    v_mul_f32_dpp v207, v39, v7 row_newbcast:4 row_mask:0xf bank_mask:0xf
    v_mfma_f32_16x16x32_bf16 v[196:199], a[20:23], v[132:135], v[196:199]
    v_cvt_pk_bf16_f32 v176, |v192|, |v193|
    v_cvt_pk_bf16_f32 v177, |v194|, |v195|
    v_mfma_f32_16x16x32_bf16 v[196:199], a[16:19], v[128:131], v[196:199]
    v_add_f32 v213, v200, v201
    v_add_f32 v218, v202, v203
    v_mov_b64 v[200:201], 0
    v_mov_b64 v[202:203], 0
    v_cvt_pk_bf16_f32 v146, v204, v205
    v_cvt_pk_bf16_f32 v147, v206, v207
    v_smfmac_f32_16x16x64_bf16 v[200:203], a[128:131], v[128:135], v242
    v_mul_f32_dpp v84, v20, v20 row_ror:8 row_mask:0xf bank_mask:0xf
    v_smfmac_f32_16x16x64_bf16 v[200:203], a[132:135], v[136:143], v242
    v_mul_f32_dpp v85, v21, v21 row_ror:8 row_mask:0xf bank_mask:0xf
    v_mfma_f32_16x16x32_bf16 v[192:195], a[32:35], v[128:131], v[104:107]
    v_mul_f32_dpp v204, v40, v8 row_newbcast:4 row_mask:0xf bank_mask:0xf
    v_mul_f32_dpp v205, v44, v12 row_newbcast:4 row_mask:0xf bank_mask:0xf
    v_mfma_f32_16x16x32_bf16 v[192:195], a[36:39], v[132:135], v[192:195]
    v_mul_f32_dpp v206, v41, v9 row_newbcast:4 row_mask:0xf bank_mask:0xf
    v_mul_f32_dpp v207, v45, v13 row_newbcast:4 row_mask:0xf bank_mask:0xf
    v_mfma_f32_16x16x32_bf16 v[192:195], a[40:43], v[136:139], v[192:195]
    v_cvt_pk_bf16_f32 v178, |v196|, |v197|
    v_cvt_pk_bf16_f32 v179, |v198|, |v199|
    v_mfma_f32_16x16x32_bf16 v[192:195], a[44:47], v[140:143], v[192:195]
    v_cvt_pk_bf16_f32 v148, v204, v205
    v_cvt_pk_bf16_f32 v149, v206, v207
    v_mfma_f32_16x16x32_bf16 v[196:199], a[60:63], v[140:143], v[108:111]
    v_mul_f32_dpp v204, v42, v10 row_newbcast:4 row_mask:0xf bank_mask:0xf
    v_mul_f32_dpp v205, v46, v14 row_newbcast:4 row_mask:0xf bank_mask:0xf
    v_mfma_f32_16x16x32_bf16 v[196:199], a[56:59], v[136:139], v[196:199]
    v_mul_f32_dpp v206, v43, v11 row_newbcast:4 row_mask:0xf bank_mask:0xf
    v_mul_f32_dpp v207, v47, v15 row_newbcast:4 row_mask:0xf bank_mask:0xf
    v_mfma_f32_16x16x32_bf16 v[196:199], a[52:55], v[132:135], v[196:199]
    v_cvt_pk_bf16_f32 v180, |v192|, |v193|
    v_cvt_pk_bf16_f32 v181, |v194|, |v195|
    v_mfma_f32_16x16x32_bf16 v[196:199], a[48:51], v[128:131], v[196:199]
    v_cvt_pk_bf16_f32 v150, v204, v205
    v_cvt_pk_bf16_f32 v151, v206, v207
    v_mfma_f32_16x16x32_bf16 v[192:195], a[64:67], v[128:131], v[112:115]
    v_mul_f32_dpp v204, v48, v16 row_newbcast:4 row_mask:0xf bank_mask:0xf
    v_mul_f32_dpp v205, v52, v20 row_newbcast:4 row_mask:0xf bank_mask:0xf
    v_mfma_f32_16x16x32_bf16 v[192:195], a[68:71], v[132:135], v[192:195]
    v_mul_f32_dpp v206, v49, v17 row_newbcast:4 row_mask:0xf bank_mask:0xf
    v_mul_f32_dpp v207, v53, v21 row_newbcast:4 row_mask:0xf bank_mask:0xf
    v_mfma_f32_16x16x32_bf16 v[192:195], a[72:75], v[136:139], v[192:195]
    v_cvt_pk_bf16_f32 v182, |v196|, |v197|
    v_cvt_pk_bf16_f32 v183, |v198|, |v199|
    v_mfma_f32_16x16x32_bf16 v[192:195], a[76:79], v[140:143], v[192:195]
    v_cvt_pk_bf16_f32 v152, v204, v205
    v_cvt_pk_bf16_f32 v153, v206, v207
    v_mfma_f32_16x16x32_bf16 v[196:199], a[92:95], v[140:143], v[116:119]
    v_mul_f32_dpp v204, v50, v18 row_newbcast:4 row_mask:0xf bank_mask:0xf
    v_mul_f32_dpp v205, v54, v22 row_newbcast:4 row_mask:0xf bank_mask:0xf
    v_mfma_f32_16x16x32_bf16 v[196:199], a[88:91], v[136:139], v[196:199]
    v_mul_f32_dpp v206, v51, v19 row_newbcast:4 row_mask:0xf bank_mask:0xf
    v_mul_f32_dpp v207, v55, v23 row_newbcast:4 row_mask:0xf bank_mask:0xf
    v_mfma_f32_16x16x32_bf16 v[196:199], a[84:87], v[132:135], v[196:199]
    v_cvt_pk_bf16_f32 v184, |v192|, |v193|
    v_cvt_pk_bf16_f32 v185, |v194|, |v195|
    v_mfma_f32_16x16x32_bf16 v[196:199], a[80:83], v[128:131], v[196:199]
    v_cvt_pk_bf16_f32 v154, v204, v205
    v_cvt_pk_bf16_f32 v155, v206, v207
    v_mfma_f32_16x16x32_bf16 v[192:195], a[96:99], v[128:131], v[120:123]
    v_mul_f32_dpp v204, v56, v24 row_newbcast:4 row_mask:0xf bank_mask:0xf
    v_mul_f32_dpp v205, v60, v28 row_newbcast:4 row_mask:0xf bank_mask:0xf
    v_mfma_f32_16x16x32_bf16 v[192:195], a[100:103], v[132:135], v[192:195]
    v_mul_f32_dpp v206, v57, v25 row_newbcast:4 row_mask:0xf bank_mask:0xf
    v_mul_f32_dpp v207, v61, v29 row_newbcast:4 row_mask:0xf bank_mask:0xf
    v_mfma_f32_16x16x32_bf16 v[192:195], a[104:107], v[136:139], v[192:195]
    v_cvt_pk_bf16_f32 v186, |v196|, |v197|
    v_cvt_pk_bf16_f32 v187, |v198|, |v199|
    v_mfma_f32_16x16x32_bf16 v[192:195], a[108:111], v[140:143], v[192:195]
    v_cvt_pk_bf16_f32 v156, v204, v205
    v_cvt_pk_bf16_f32 v157, v206, v207
    v_mfma_f32_16x16x32_bf16 v[196:199], a[124:127], v[140:143], v[124:127]
    v_mul_f32_dpp v204, v58, v26 row_newbcast:4 row_mask:0xf bank_mask:0xf
    v_mul_f32_dpp v205, v62, v30 row_newbcast:4 row_mask:0xf bank_mask:0xf
    v_mfma_f32_16x16x32_bf16 v[196:199], a[120:123], v[136:139], v[196:199]
    v_mul_f32_dpp v206, v59, v27 row_newbcast:4 row_mask:0xf bank_mask:0xf
    v_mul_f32_dpp v207, v63, v31 row_newbcast:4 row_mask:0xf bank_mask:0xf
    v_mfma_f32_16x16x32_bf16 v[196:199], a[116:119], v[132:135], v[196:199]
    v_cvt_pk_bf16_f32 v188, |v192|, |v193|
    v_cvt_pk_bf16_f32 v189, |v194|, |v195|
    v_mfma_f32_16x16x32_bf16 v[196:199], a[112:115], v[128:131], v[196:199]
    v_cvt_pk_bf16_f32 v158, v204, v205
    v_cvt_pk_bf16_f32 v159, v206, v207
    v_mfma_f32_16x16x32_bf16 v[192:195], a[0:3], v[144:147], v[96:99]
    v_mul_f32_dpp v204, v32, v0 row_newbcast:3 row_mask:0xf bank_mask:0xf
    v_mul_f32_dpp v205, v36, v4 row_newbcast:3 row_mask:0xf bank_mask:0xf
    v_mfma_f32_16x16x32_bf16 v[192:195], a[4:7], v[148:151], v[192:195]
    v_mul_f32_dpp v206, v33, v1 row_newbcast:3 row_mask:0xf bank_mask:0xf
    v_mul_f32_dpp v207, v37, v5 row_newbcast:3 row_mask:0xf bank_mask:0xf
    v_mfma_f32_16x16x32_bf16 v[192:195], a[8:11], v[152:155], v[192:195]
    v_cvt_pk_bf16_f32 v190, |v196|, |v197|
    v_cvt_pk_bf16_f32 v191, |v198|, |v199|
    v_mfma_f32_16x16x32_bf16 v[192:195], a[12:15], v[156:159], v[192:195]
    v_cvt_pk_bf16_f32 v128, v204, v205
    v_cvt_pk_bf16_f32 v129, v206, v207
    v_smfmac_f32_16x16x64_bf16 v[200:203], a[136:139], v[176:183], v242
    v_mul_f32_dpp v86, v22, v22 row_ror:8 row_mask:0xf bank_mask:0xf
    v_smfmac_f32_16x16x64_bf16 v[200:203], a[140:143], v[184:191], v242
    v_mul_f32_dpp v87, v23, v23 row_ror:8 row_mask:0xf bank_mask:0xf
    v_smfmac_f32_16x16x64_bf16 v[200:203], a[144:147], v[144:151], v242
    v_mul_f32_dpp v88, v24, v24 row_ror:8 row_mask:0xf bank_mask:0xf
    v_smfmac_f32_16x16x64_bf16 v[200:203], a[148:151], v[152:159], v242
    v_mul_f32_dpp v89, v25, v25 row_ror:8 row_mask:0xf bank_mask:0xf
    v_mul_f32_dpp v90, v26, v26 row_ror:8 row_mask:0xf bank_mask:0xf
    v_mul_f32_dpp v91, v27, v27 row_ror:8 row_mask:0xf bank_mask:0xf
    v_mul_f32_dpp v92, v28, v28 row_ror:8 row_mask:0xf bank_mask:0xf
    v_mul_f32_dpp v93, v29, v29 row_ror:8 row_mask:0xf bank_mask:0xf
    v_mul_f32_dpp v94, v30, v30 row_ror:8 row_mask:0xf bank_mask:0xf
    v_mul_f32_dpp v95, v31, v31 row_ror:8 row_mask:0xf bank_mask:0xf
    v_mfma_f32_16x16x32_bf16 v[196:199], a[28:31], v[156:159], v[100:103]
    v_mul_f32_dpp v204, v34, v2 row_newbcast:3 row_mask:0xf bank_mask:0xf
    v_mul_f32_dpp v205, v38, v6 row_newbcast:3 row_mask:0xf bank_mask:0xf
    v_mfma_f32_16x16x32_bf16 v[196:199], a[24:27], v[152:155], v[196:199]
    v_mul_f32_dpp v206, v35, v3 row_newbcast:3 row_mask:0xf bank_mask:0xf
    v_mul_f32_dpp v207, v39, v7 row_newbcast:3 row_mask:0xf bank_mask:0xf
    v_mfma_f32_16x16x32_bf16 v[196:199], a[20:23], v[148:151], v[196:199]
    v_cvt_pk_bf16_f32 v176, |v192|, |v193|
    v_cvt_pk_bf16_f32 v177, |v194|, |v195|
    v_mfma_f32_16x16x32_bf16 v[196:199], a[16:19], v[144:147], v[196:199]
    v_cvt_pk_bf16_f32 v130, v204, v205
    v_cvt_pk_bf16_f32 v131, v206, v207
    v_mfma_f32_16x16x32_bf16 v[192:195], a[32:35], v[144:147], v[104:107]
    v_mul_f32_dpp v204, v40, v8 row_newbcast:3 row_mask:0xf bank_mask:0xf
    v_mul_f32_dpp v205, v44, v12 row_newbcast:3 row_mask:0xf bank_mask:0xf
    v_mfma_f32_16x16x32_bf16 v[192:195], a[36:39], v[148:151], v[192:195]
    v_mul_f32_dpp v206, v41, v9 row_newbcast:3 row_mask:0xf bank_mask:0xf
    v_mul_f32_dpp v207, v45, v13 row_newbcast:3 row_mask:0xf bank_mask:0xf
    v_mfma_f32_16x16x32_bf16 v[192:195], a[40:43], v[152:155], v[192:195]
    v_cvt_pk_bf16_f32 v178, |v196|, |v197|
    v_cvt_pk_bf16_f32 v179, |v198|, |v199|
    v_mfma_f32_16x16x32_bf16 v[192:195], a[44:47], v[156:159], v[192:195]
    s_mov_b64 exec, s[36:37]
    v_cvt_pk_bf16_f32 v160, v64, v68
    v_cvt_pk_bf16_f32 v161, v65, v69
    v_cvt_pk_bf16_f32 v162, v66, v70
    v_cvt_pk_bf16_f32 v163, v67, v71
    v_cvt_pk_bf16_f32 v164, v72, v76
    v_cvt_pk_bf16_f32 v165, v73, v77
    v_cvt_pk_bf16_f32 v166, v74, v78
    v_cvt_pk_bf16_f32 v167, v75, v79
    v_cvt_pk_bf16_f32 v168, v80, v84
    v_cvt_pk_bf16_f32 v169, v81, v85
    v_cvt_pk_bf16_f32 v170, v82, v86
    v_cvt_pk_bf16_f32 v171, v83, v87
    v_cvt_pk_bf16_f32 v172, v88, v92
    v_cvt_pk_bf16_f32 v173, v89, v93
    v_cvt_pk_bf16_f32 v174, v90, v94
    v_cvt_pk_bf16_f32 v175, v91, v95
    s_mov_b64 exec, -1
    v_cvt_pk_bf16_f32 v132, v204, v205
    v_cvt_pk_bf16_f32 v133, v206, v207
    v_mfma_f32_16x16x32_bf16 v[196:199], a[60:63], v[156:159], v[108:111]
    s_not_b64 s[36:37], s[36:37]
    v_mul_f32_dpp v204, v42, v10 row_newbcast:3 row_mask:0xf bank_mask:0xf
    v_mul_f32_dpp v205, v46, v14 row_newbcast:3 row_mask:0xf bank_mask:0xf
    v_mfma_f32_16x16x32_bf16 v[196:199], a[56:59], v[152:155], v[196:199]
    v_mul_f32_dpp v206, v43, v11 row_newbcast:3 row_mask:0xf bank_mask:0xf
    v_mul_f32_dpp v207, v47, v15 row_newbcast:3 row_mask:0xf bank_mask:0xf
    v_mfma_f32_16x16x32_bf16 v[196:199], a[52:55], v[148:151], v[196:199]
    v_cvt_pk_bf16_f32 v180, |v192|, |v193|
    v_cvt_pk_bf16_f32 v181, |v194|, |v195|
    v_mfma_f32_16x16x32_bf16 v[196:199], a[48:51], v[144:147], v[196:199]
    buffer_load_dwordx4 v[68:71], v240, s[24:27], 0 offen offset:0
    v_cvt_pk_bf16_f32 v134, v204, v205
    v_cvt_pk_bf16_f32 v135, v206, v207
    v_mfma_f32_16x16x32_bf16 v[192:195], a[64:67], v[144:147], v[112:115]
    v_mul_f32_dpp v204, v48, v16 row_newbcast:3 row_mask:0xf bank_mask:0xf
    v_mul_f32_dpp v205, v52, v20 row_newbcast:3 row_mask:0xf bank_mask:0xf
    v_mfma_f32_16x16x32_bf16 v[192:195], a[68:71], v[148:151], v[192:195]
    v_mul_f32_dpp v206, v49, v17 row_newbcast:3 row_mask:0xf bank_mask:0xf
    v_mul_f32_dpp v207, v53, v21 row_newbcast:3 row_mask:0xf bank_mask:0xf
    v_mfma_f32_16x16x32_bf16 v[192:195], a[72:75], v[152:155], v[192:195]
    v_cvt_pk_bf16_f32 v182, |v196|, |v197|
    v_cvt_pk_bf16_f32 v183, |v198|, |v199|
    v_mfma_f32_16x16x32_bf16 v[192:195], a[76:79], v[156:159], v[192:195]
    v_cvt_pk_bf16_f32 v136, v204, v205
    v_cvt_pk_bf16_f32 v137, v206, v207
    v_mfma_f32_16x16x32_bf16 v[196:199], a[92:95], v[156:159], v[116:119]
    v_mul_f32_dpp v204, v50, v18 row_newbcast:3 row_mask:0xf bank_mask:0xf
    v_mul_f32_dpp v205, v54, v22 row_newbcast:3 row_mask:0xf bank_mask:0xf
    v_mfma_f32_16x16x32_bf16 v[196:199], a[88:91], v[152:155], v[196:199]
    v_mul_f32_dpp v206, v51, v19 row_newbcast:3 row_mask:0xf bank_mask:0xf
    v_mul_f32_dpp v207, v55, v23 row_newbcast:3 row_mask:0xf bank_mask:0xf
    v_mfma_f32_16x16x32_bf16 v[196:199], a[84:87], v[148:151], v[196:199]
    v_cvt_pk_bf16_f32 v184, |v192|, |v193|
    v_cvt_pk_bf16_f32 v185, |v194|, |v195|
    v_mfma_f32_16x16x32_bf16 v[196:199], a[80:83], v[144:147], v[196:199]
    buffer_load_dwordx4 v[76:79], v240, s[24:27], 0 offen offset:16
    v_cvt_pk_bf16_f32 v138, v204, v205
    v_cvt_pk_bf16_f32 v139, v206, v207
    v_mfma_f32_16x16x32_bf16 v[192:195], a[96:99], v[144:147], v[120:123]
    v_mul_f32_dpp v204, v56, v24 row_newbcast:3 row_mask:0xf bank_mask:0xf
    v_mul_f32_dpp v205, v60, v28 row_newbcast:3 row_mask:0xf bank_mask:0xf
    v_mfma_f32_16x16x32_bf16 v[192:195], a[100:103], v[148:151], v[192:195]
    v_mul_f32_dpp v206, v57, v25 row_newbcast:3 row_mask:0xf bank_mask:0xf
    v_mul_f32_dpp v207, v61, v29 row_newbcast:3 row_mask:0xf bank_mask:0xf
    v_mfma_f32_16x16x32_bf16 v[192:195], a[104:107], v[152:155], v[192:195]
    v_cvt_pk_bf16_f32 v186, |v196|, |v197|
    v_cvt_pk_bf16_f32 v187, |v198|, |v199|
    v_mfma_f32_16x16x32_bf16 v[192:195], a[108:111], v[156:159], v[192:195]
    v_cvt_pk_bf16_f32 v140, v204, v205
    v_cvt_pk_bf16_f32 v141, v206, v207
    v_mfma_f32_16x16x32_bf16 v[196:199], a[124:127], v[156:159], v[124:127]
    v_mul_f32_dpp v204, v58, v26 row_newbcast:3 row_mask:0xf bank_mask:0xf
    v_mul_f32_dpp v205, v62, v30 row_newbcast:3 row_mask:0xf bank_mask:0xf
    v_mfma_f32_16x16x32_bf16 v[196:199], a[120:123], v[152:155], v[196:199]
    v_mul_f32_dpp v206, v59, v27 row_newbcast:3 row_mask:0xf bank_mask:0xf
    v_mul_f32_dpp v207, v63, v31 row_newbcast:3 row_mask:0xf bank_mask:0xf
    v_mfma_f32_16x16x32_bf16 v[196:199], a[116:119], v[148:151], v[196:199]
    v_cvt_pk_bf16_f32 v188, |v192|, |v193|
    v_cvt_pk_bf16_f32 v189, |v194|, |v195|
    v_mfma_f32_16x16x32_bf16 v[196:199], a[112:115], v[144:147], v[196:199]
    buffer_load_dwordx4 v[84:87], v240, s[24:27], 0 offen offset:32
    v_cvt_pk_bf16_f32 v142, v204, v205
    v_cvt_pk_bf16_f32 v143, v206, v207
    v_mfma_f32_16x16x32_bf16 v[192:195], a[0:3], v[128:131], v[96:99]
    v_mul_f32_dpp v204, v32, v0 row_newbcast:0 row_mask:0xf bank_mask:0xf
    v_mul_f32_dpp v205, v36, v4 row_newbcast:0 row_mask:0xf bank_mask:0xf
    v_mfma_f32_16x16x32_bf16 v[192:195], a[4:7], v[132:135], v[192:195]
    v_mul_f32_dpp v206, v33, v1 row_newbcast:0 row_mask:0xf bank_mask:0xf
    v_mul_f32_dpp v207, v37, v5 row_newbcast:0 row_mask:0xf bank_mask:0xf
    v_mfma_f32_16x16x32_bf16 v[192:195], a[8:11], v[136:139], v[192:195]
    v_cvt_pk_bf16_f32 v190, |v196|, |v197|
    v_cvt_pk_bf16_f32 v191, |v198|, |v199|
    v_mfma_f32_16x16x32_bf16 v[192:195], a[12:15], v[140:143], v[192:195]
    v_cvt_pk_bf16_f32 v144, v204, v205
    v_cvt_pk_bf16_f32 v145, v206, v207
    v_smfmac_f32_16x16x64_bf16 v[200:203], a[152:155], v[176:183], v242
    s_nop 0
    v_smfmac_f32_16x16x64_bf16 v[200:203], a[156:159], v[184:191], v242
    v_smfmac_f32_16x16x64_bf16 v[200:203], a[160:163], v[128:135], v242
    v_smfmac_f32_16x16x64_bf16 v[200:203], a[164:167], v[136:143], v242
    v_mfma_f32_16x16x32_bf16 v[196:199], a[28:31], v[140:143], v[100:103]
    v_mul_f32_dpp v204, v34, v2 row_newbcast:0 row_mask:0xf bank_mask:0xf
    v_mul_f32_dpp v205, v38, v6 row_newbcast:0 row_mask:0xf bank_mask:0xf
    v_mfma_f32_16x16x32_bf16 v[196:199], a[24:27], v[136:139], v[196:199]
    v_mul_f32_dpp v206, v35, v3 row_newbcast:0 row_mask:0xf bank_mask:0xf
    v_mul_f32_dpp v207, v39, v7 row_newbcast:0 row_mask:0xf bank_mask:0xf
    v_mfma_f32_16x16x32_bf16 v[196:199], a[20:23], v[132:135], v[196:199]
    v_cvt_pk_bf16_f32 v176, |v192|, |v193|
    v_cvt_pk_bf16_f32 v177, |v194|, |v195|
    v_mfma_f32_16x16x32_bf16 v[196:199], a[16:19], v[128:131], v[196:199]
    buffer_load_dwordx4 v[92:95], v240, s[24:27], 0 offen offset:48
    v_cvt_pk_bf16_f32 v146, v204, v205
    v_cvt_pk_bf16_f32 v147, v206, v207
    v_mfma_f32_16x16x32_bf16 v[192:195], a[32:35], v[128:131], v[104:107]
    v_mul_f32_dpp v204, v40, v8 row_newbcast:0 row_mask:0xf bank_mask:0xf
    v_mul_f32_dpp v205, v44, v12 row_newbcast:0 row_mask:0xf bank_mask:0xf
    v_mfma_f32_16x16x32_bf16 v[192:195], a[36:39], v[132:135], v[192:195]
    v_mul_f32_dpp v206, v41, v9 row_newbcast:0 row_mask:0xf bank_mask:0xf
    v_mul_f32_dpp v207, v45, v13 row_newbcast:0 row_mask:0xf bank_mask:0xf
    v_mfma_f32_16x16x32_bf16 v[192:195], a[40:43], v[136:139], v[192:195]
    v_cvt_pk_bf16_f32 v178, |v196|, |v197|
    v_cvt_pk_bf16_f32 v179, |v198|, |v199|
    v_mfma_f32_16x16x32_bf16 v[192:195], a[44:47], v[140:143], v[192:195]
    v_cvt_pk_bf16_f32 v148, v204, v205
    v_cvt_pk_bf16_f32 v149, v206, v207
    v_mfma_f32_16x16x32_bf16 v[196:199], a[60:63], v[140:143], v[108:111]
    v_mul_f32_dpp v204, v42, v10 row_newbcast:0 row_mask:0xf bank_mask:0xf
    v_mul_f32_dpp v205, v46, v14 row_newbcast:0 row_mask:0xf bank_mask:0xf
    v_mfma_f32_16x16x32_bf16 v[196:199], a[56:59], v[136:139], v[196:199]
    v_mul_f32_dpp v206, v43, v11 row_newbcast:0 row_mask:0xf bank_mask:0xf
    v_mul_f32_dpp v207, v47, v15 row_newbcast:0 row_mask:0xf bank_mask:0xf
    v_mfma_f32_16x16x32_bf16 v[196:199], a[52:55], v[132:135], v[196:199]
    v_cvt_pk_bf16_f32 v180, |v192|, |v193|
    v_cvt_pk_bf16_f32 v181, |v194|, |v195|
    v_mfma_f32_16x16x32_bf16 v[196:199], a[48:51], v[128:131], v[196:199]
    buffer_load_dword v240, v245, s[20:23], s33 offen
    v_cvt_pk_bf16_f32 v150, v204, v205
    v_cvt_pk_bf16_f32 v151, v206, v207
    v_mfma_f32_16x16x32_bf16 v[192:195], a[64:67], v[128:131], v[112:115]
    s_add_u32 s33, s33, 104
    v_mul_f32_dpp v204, v48, v16 row_newbcast:0 row_mask:0xf bank_mask:0xf
    v_mul_f32_dpp v205, v52, v20 row_newbcast:0 row_mask:0xf bank_mask:0xf
    v_mfma_f32_16x16x32_bf16 v[192:195], a[68:71], v[132:135], v[192:195]
    s_cmp_lt_u32 s34, 2
    v_mul_f32_dpp v206, v49, v17 row_newbcast:0 row_mask:0xf bank_mask:0xf
    v_mul_f32_dpp v207, v53, v21 row_newbcast:0 row_mask:0xf bank_mask:0xf
    v_mfma_f32_16x16x32_bf16 v[192:195], a[72:75], v[136:139], v[192:195]
    s_cselect_b32 s33, s33, 0x7fff0000
    v_cvt_pk_bf16_f32 v182, |v196|, |v197|
    v_cvt_pk_bf16_f32 v183, |v198|, |v199|
    v_mfma_f32_16x16x32_bf16 v[192:195], a[76:79], v[140:143], v[192:195]
    v_cvt_pk_bf16_f32 v152, v204, v205
    v_cvt_pk_bf16_f32 v153, v206, v207
    v_mfma_f32_16x16x32_bf16 v[196:199], a[92:95], v[140:143], v[116:119]
    v_mul_f32_dpp v204, v50, v18 row_newbcast:0 row_mask:0xf bank_mask:0xf
    v_mul_f32_dpp v205, v54, v22 row_newbcast:0 row_mask:0xf bank_mask:0xf
    v_mfma_f32_16x16x32_bf16 v[196:199], a[88:91], v[136:139], v[196:199]
    v_mul_f32_dpp v206, v51, v19 row_newbcast:0 row_mask:0xf bank_mask:0xf
    v_mul_f32_dpp v207, v55, v23 row_newbcast:0 row_mask:0xf bank_mask:0xf
    v_mfma_f32_16x16x32_bf16 v[196:199], a[84:87], v[132:135], v[196:199]
    v_cvt_pk_bf16_f32 v184, |v192|, |v193|
    v_cvt_pk_bf16_f32 v185, |v194|, |v195|
    v_mfma_f32_16x16x32_bf16 v[196:199], a[80:83], v[128:131], v[196:199]
    v_cvt_pk_bf16_f32 v154, v204, v205
    v_cvt_pk_bf16_f32 v155, v206, v207
    v_mfma_f32_16x16x32_bf16 v[192:195], a[96:99], v[128:131], v[120:123]
    v_mul_f32_dpp v204, v56, v24 row_newbcast:0 row_mask:0xf bank_mask:0xf
    v_mul_f32_dpp v205, v60, v28 row_newbcast:0 row_mask:0xf bank_mask:0xf
    v_mfma_f32_16x16x32_bf16 v[192:195], a[100:103], v[132:135], v[192:195]
    v_mul_f32_dpp v206, v57, v25 row_newbcast:0 row_mask:0xf bank_mask:0xf
    v_mul_f32_dpp v207, v61, v29 row_newbcast:0 row_mask:0xf bank_mask:0xf
    v_mfma_f32_16x16x32_bf16 v[192:195], a[104:107], v[136:139], v[192:195]
    v_cvt_pk_bf16_f32 v186, |v196|, |v197|
    v_cvt_pk_bf16_f32 v187, |v198|, |v199|
    v_mfma_f32_16x16x32_bf16 v[192:195], a[108:111], v[140:143], v[192:195]
    v_cvt_pk_bf16_f32 v156, v204, v205
    v_cvt_pk_bf16_f32 v157, v206, v207
    v_mfma_f32_16x16x32_bf16 v[196:199], a[124:127], v[140:143], v[124:127]
    v_mul_f32_dpp v204, v58, v26 row_newbcast:0 row_mask:0xf bank_mask:0xf
    v_mul_f32_dpp v205, v62, v30 row_newbcast:0 row_mask:0xf bank_mask:0xf
    v_mfma_f32_16x16x32_bf16 v[196:199], a[120:123], v[136:139], v[196:199]
    v_mul_f32_dpp v206, v59, v27 row_newbcast:0 row_mask:0xf bank_mask:0xf
    v_mul_f32_dpp v207, v63, v31 row_newbcast:0 row_mask:0xf bank_mask:0xf
    v_mfma_f32_16x16x32_bf16 v[196:199], a[116:119], v[132:135], v[196:199]
    v_cvt_pk_bf16_f32 v188, |v192|, |v193|
    v_cvt_pk_bf16_f32 v189, |v194|, |v195|
    v_mfma_f32_16x16x32_bf16 v[196:199], a[112:115], v[128:131], v[196:199]
    v_cvt_pk_bf16_f32 v158, v204, v205
    v_cvt_pk_bf16_f32 v159, v206, v207
    v_mfma_f32_16x16x32_bf16 v[192:195], a[0:3], v[144:147], v[96:99]
    v_mul_f32_dpp v204, v32, v0 row_newbcast:2 row_mask:0xf bank_mask:0xf
    v_mul_f32_dpp v205, v36, v4 row_newbcast:2 row_mask:0xf bank_mask:0xf
    v_mfma_f32_16x16x32_bf16 v[192:195], a[4:7], v[148:151], v[192:195]
    v_mul_f32_dpp v206, v33, v1 row_newbcast:2 row_mask:0xf bank_mask:0xf
    v_mul_f32_dpp v207, v37, v5 row_newbcast:2 row_mask:0xf bank_mask:0xf
    v_mfma_f32_16x16x32_bf16 v[192:195], a[8:11], v[152:155], v[192:195]
    v_cvt_pk_bf16_f32 v190, |v196|, |v197|
    v_cvt_pk_bf16_f32 v191, |v198|, |v199|
    v_mfma_f32_16x16x32_bf16 v[192:195], a[12:15], v[156:159], v[192:195]
    s_waitcnt vmcnt(4)
    v_cvt_pk_bf16_f32 v128, v204, v205
    v_cvt_pk_bf16_f32 v129, v206, v207
    v_smfmac_f32_16x16x64_bf16 v[200:203], a[168:171], v[176:183], v242
    v_lshlrev_b32 v64, 16, v68
    v_smfmac_f32_16x16x64_bf16 v[200:203], a[172:175], v[184:191], v242
    v_and_b32 v68, s41, v68
    v_smfmac_f32_16x16x64_bf16 v[200:203], a[176:179], v[144:151], v242
    v_lshlrev_b32 v65, 16, v69
    v_smfmac_f32_16x16x64_bf16 v[200:203], a[180:183], v[152:159], v242
    v_and_b32 v69, s41, v69
    v_mfma_f32_16x16x32_bf16 v[196:199], a[28:31], v[156:159], v[100:103]
    v_mul_f32_dpp v204, v34, v2 row_newbcast:2 row_mask:0xf bank_mask:0xf
    v_mul_f32_dpp v205, v38, v6 row_newbcast:2 row_mask:0xf bank_mask:0xf
    v_mfma_f32_16x16x32_bf16 v[196:199], a[24:27], v[152:155], v[196:199]
    v_mul_f32_dpp v206, v35, v3 row_newbcast:2 row_mask:0xf bank_mask:0xf
    v_mul_f32_dpp v207, v39, v7 row_newbcast:2 row_mask:0xf bank_mask:0xf
    v_mfma_f32_16x16x32_bf16 v[196:199], a[20:23], v[148:151], v[196:199]
    v_cvt_pk_bf16_f32 v176, |v192|, |v193|
    v_cvt_pk_bf16_f32 v177, |v194|, |v195|
    v_mfma_f32_16x16x32_bf16 v[196:199], a[16:19], v[144:147], v[196:199]
    v_cvt_pk_bf16_f32 v130, v204, v205
    v_cvt_pk_bf16_f32 v131, v206, v207
    v_mfma_f32_16x16x32_bf16 v[192:195], a[32:35], v[144:147], v[104:107]
    v_mul_f32_dpp v204, v40, v8 row_newbcast:2 row_mask:0xf bank_mask:0xf
    v_mul_f32_dpp v205, v44, v12 row_newbcast:2 row_mask:0xf bank_mask:0xf
    v_mfma_f32_16x16x32_bf16 v[192:195], a[36:39], v[148:151], v[192:195]
    v_mul_f32_dpp v206, v41, v9 row_newbcast:2 row_mask:0xf bank_mask:0xf
    v_mul_f32_dpp v207, v45, v13 row_newbcast:2 row_mask:0xf bank_mask:0xf
    v_mfma_f32_16x16x32_bf16 v[192:195], a[40:43], v[152:155], v[192:195]
    v_cvt_pk_bf16_f32 v178, |v196|, |v197|
    v_cvt_pk_bf16_f32 v179, |v198|, |v199|
    v_mfma_f32_16x16x32_bf16 v[192:195], a[44:47], v[156:159], v[192:195]
    v_cvt_pk_bf16_f32 v132, v204, v205
    v_cvt_pk_bf16_f32 v133, v206, v207
    v_mfma_f32_16x16x32_bf16 v[196:199], a[60:63], v[156:159], v[108:111]
    v_mul_f32_dpp v204, v42, v10 row_newbcast:2 row_mask:0xf bank_mask:0xf
    v_mul_f32_dpp v205, v46, v14 row_newbcast:2 row_mask:0xf bank_mask:0xf
    v_mfma_f32_16x16x32_bf16 v[196:199], a[56:59], v[152:155], v[196:199]
    v_mul_f32_dpp v206, v43, v11 row_newbcast:2 row_mask:0xf bank_mask:0xf
    v_mul_f32_dpp v207, v47, v15 row_newbcast:2 row_mask:0xf bank_mask:0xf
    v_mfma_f32_16x16x32_bf16 v[196:199], a[52:55], v[148:151], v[196:199]
    v_cvt_pk_bf16_f32 v180, |v192|, |v193|
    v_cvt_pk_bf16_f32 v181, |v194|, |v195|
    v_mfma_f32_16x16x32_bf16 v[196:199], a[48:51], v[144:147], v[196:199]
    v_cvt_pk_bf16_f32 v134, v204, v205
    v_cvt_pk_bf16_f32 v135, v206, v207
    v_mfma_f32_16x16x32_bf16 v[192:195], a[64:67], v[144:147], v[112:115]
    v_mul_f32_dpp v204, v48, v16 row_newbcast:2 row_mask:0xf bank_mask:0xf
    v_mul_f32_dpp v205, v52, v20 row_newbcast:2 row_mask:0xf bank_mask:0xf
    v_mfma_f32_16x16x32_bf16 v[192:195], a[68:71], v[148:151], v[192:195]
    v_mul_f32_dpp v206, v49, v17 row_newbcast:2 row_mask:0xf bank_mask:0xf
    v_mul_f32_dpp v207, v53, v21 row_newbcast:2 row_mask:0xf bank_mask:0xf
    v_mfma_f32_16x16x32_bf16 v[192:195], a[72:75], v[152:155], v[192:195]
    v_cvt_pk_bf16_f32 v182, |v196|, |v197|
    v_cvt_pk_bf16_f32 v183, |v198|, |v199|
    v_mfma_f32_16x16x32_bf16 v[192:195], a[76:79], v[156:159], v[192:195]
    v_cvt_pk_bf16_f32 v136, v204, v205
    v_cvt_pk_bf16_f32 v137, v206, v207
    v_mfma_f32_16x16x32_bf16 v[196:199], a[92:95], v[156:159], v[116:119]
    v_mul_f32_dpp v204, v50, v18 row_newbcast:2 row_mask:0xf bank_mask:0xf
    v_mul_f32_dpp v205, v54, v22 row_newbcast:2 row_mask:0xf bank_mask:0xf
    v_mfma_f32_16x16x32_bf16 v[196:199], a[88:91], v[152:155], v[196:199]
    v_mul_f32_dpp v206, v51, v19 row_newbcast:2 row_mask:0xf bank_mask:0xf
    v_mul_f32_dpp v207, v55, v23 row_newbcast:2 row_mask:0xf bank_mask:0xf
    v_mfma_f32_16x16x32_bf16 v[196:199], a[84:87], v[148:151], v[196:199]
    v_cvt_pk_bf16_f32 v184, |v192|, |v193|
    v_cvt_pk_bf16_f32 v185, |v194|, |v195|
    v_mfma_f32_16x16x32_bf16 v[196:199], a[80:83], v[144:147], v[196:199]
    v_cvt_pk_bf16_f32 v138, v204, v205
    v_cvt_pk_bf16_f32 v139, v206, v207
    v_mfma_f32_16x16x32_bf16 v[192:195], a[96:99], v[144:147], v[120:123]
    v_mul_f32_dpp v204, v56, v24 row_newbcast:2 row_mask:0xf bank_mask:0xf
    v_mul_f32_dpp v205, v60, v28 row_newbcast:2 row_mask:0xf bank_mask:0xf
    v_mfma_f32_16x16x32_bf16 v[192:195], a[100:103], v[148:151], v[192:195]
    v_mul_f32_dpp v206, v57, v25 row_newbcast:2 row_mask:0xf bank_mask:0xf
    v_mul_f32_dpp v207, v61, v29 row_newbcast:2 row_mask:0xf bank_mask:0xf
    v_mfma_f32_16x16x32_bf16 v[192:195], a[104:107], v[152:155], v[192:195]
    v_cvt_pk_bf16_f32 v186, |v196|, |v197|
    v_cvt_pk_bf16_f32 v187, |v198|, |v199|
    v_mfma_f32_16x16x32_bf16 v[192:195], a[108:111], v[156:159], v[192:195]
    v_cvt_pk_bf16_f32 v140, v204, v205
    v_cvt_pk_bf16_f32 v141, v206, v207
    v_mfma_f32_16x16x32_bf16 v[196:199], a[124:127], v[156:159], v[124:127]
    v_mul_f32_dpp v204, v58, v26 row_newbcast:2 row_mask:0xf bank_mask:0xf
    v_mul_f32_dpp v205, v62, v30 row_newbcast:2 row_mask:0xf bank_mask:0xf
    v_mfma_f32_16x16x32_bf16 v[196:199], a[120:123], v[152:155], v[196:199]
    v_mul_f32_dpp v206, v59, v27 row_newbcast:2 row_mask:0xf bank_mask:0xf
    v_mul_f32_dpp v207, v63, v31 row_newbcast:2 row_mask:0xf bank_mask:0xf
    v_mfma_f32_16x16x32_bf16 v[196:199], a[116:119], v[148:151], v[196:199]
    v_cvt_pk_bf16_f32 v188, |v192|, |v193|
    v_cvt_pk_bf16_f32 v189, |v194|, |v195|
    v_mfma_f32_16x16x32_bf16 v[196:199], a[112:115], v[144:147], v[196:199]
    v_cvt_pk_bf16_f32 v142, v204, v205
    v_cvt_pk_bf16_f32 v143, v206, v207
    v_mfma_f32_16x16x32_bf16 v[192:195], a[0:3], v[128:131], v[96:99]
    v_mul_f32_dpp v204, v32, v0 row_newbcast:9 row_mask:0xf bank_mask:0xf
    v_mul_f32_dpp v205, v36, v4 row_newbcast:9 row_mask:0xf bank_mask:0xf
    v_mfma_f32_16x16x32_bf16 v[192:195], a[4:7], v[132:135], v[192:195]
    v_mul_f32_dpp v206, v33, v1 row_newbcast:9 row_mask:0xf bank_mask:0xf
    v_mul_f32_dpp v207, v37, v5 row_newbcast:9 row_mask:0xf bank_mask:0xf
    v_mfma_f32_16x16x32_bf16 v[192:195], a[8:11], v[136:139], v[192:195]
    v_cvt_pk_bf16_f32 v190, |v196|, |v197|
    v_cvt_pk_bf16_f32 v191, |v198|, |v199|
    v_mfma_f32_16x16x32_bf16 v[192:195], a[12:15], v[140:143], v[192:195]
    v_cvt_pk_bf16_f32 v144, v204, v205
    v_cvt_pk_bf16_f32 v145, v206, v207
    v_smfmac_f32_16x16x64_bf16 v[200:203], a[184:187], v[176:183], v242
    v_lshlrev_b32 v66, 16, v70
    v_smfmac_f32_16x16x64_bf16 v[200:203], a[188:191], v[184:191], v242
    v_and_b32 v70, s41, v70
    v_mfma_f32_16x16x32_bf16 v[196:199], a[28:31], v[140:143], v[100:103]
    v_mul_f32_dpp v204, v34, v2 row_newbcast:9 row_mask:0xf bank_mask:0xf
    v_mul_f32_dpp v205, v38, v6 row_newbcast:9 row_mask:0xf bank_mask:0xf
    v_mfma_f32_16x16x32_bf16 v[196:199], a[24:27], v[136:139], v[196:199]
    v_mul_f32_dpp v206, v35, v3 row_newbcast:9 row_mask:0xf bank_mask:0xf
    v_mul_f32_dpp v207, v39, v7 row_newbcast:9 row_mask:0xf bank_mask:0xf
    v_mfma_f32_16x16x32_bf16 v[196:199], a[20:23], v[132:135], v[196:199]
    v_cvt_pk_bf16_f32 v176, |v192|, |v193|
    v_cvt_pk_bf16_f32 v177, |v194|, |v195|
    v_mfma_f32_16x16x32_bf16 v[196:199], a[16:19], v[128:131], v[196:199]
    v_add_f32 v214, v200, v201
    v_add_f32 v219, v202, v203
    v_mov_b64 v[200:201], 0
    v_mov_b64 v[202:203], 0
    v_cvt_pk_bf16_f32 v146, v204, v205
    v_cvt_pk_bf16_f32 v147, v206, v207
    v_smfmac_f32_16x16x64_bf16 v[200:203], a[128:131], v[128:135], v242
    v_lshlrev_b32 v67, 16, v71
    v_smfmac_f32_16x16x64_bf16 v[200:203], a[132:135], v[136:143], v242
    v_and_b32 v71, s41, v71
    v_mfma_f32_16x16x32_bf16 v[192:195], a[32:35], v[128:131], v[104:107]
    v_mul_f32_dpp v204, v40, v8 row_newbcast:9 row_mask:0xf bank_mask:0xf
    v_mul_f32_dpp v205, v44, v12 row_newbcast:9 row_mask:0xf bank_mask:0xf
    v_mfma_f32_16x16x32_bf16 v[192:195], a[36:39], v[132:135], v[192:195]
    v_mul_f32_dpp v206, v41, v9 row_newbcast:9 row_mask:0xf bank_mask:0xf
    v_mul_f32_dpp v207, v45, v13 row_newbcast:9 row_mask:0xf bank_mask:0xf
    v_mfma_f32_16x16x32_bf16 v[192:195], a[40:43], v[136:139], v[192:195]
    v_cvt_pk_bf16_f32 v178, |v196|, |v197|
    v_cvt_pk_bf16_f32 v179, |v198|, |v199|
    v_mfma_f32_16x16x32_bf16 v[192:195], a[44:47], v[140:143], v[192:195]
    v_cvt_pk_bf16_f32 v148, v204, v205
    v_cvt_pk_bf16_f32 v149, v206, v207
    v_mfma_f32_16x16x32_bf16 v[196:199], a[60:63], v[140:143], v[108:111]
    v_mul_f32_dpp v204, v42, v10 row_newbcast:9 row_mask:0xf bank_mask:0xf
    v_mul_f32_dpp v205, v46, v14 row_newbcast:9 row_mask:0xf bank_mask:0xf
    v_mfma_f32_16x16x32_bf16 v[196:199], a[56:59], v[136:139], v[196:199]
    v_mul_f32_dpp v206, v43, v11 row_newbcast:9 row_mask:0xf bank_mask:0xf
    v_mul_f32_dpp v207, v47, v15 row_newbcast:9 row_mask:0xf bank_mask:0xf
    v_mfma_f32_16x16x32_bf16 v[196:199], a[52:55], v[132:135], v[196:199]
    v_cvt_pk_bf16_f32 v180, |v192|, |v193|
    v_cvt_pk_bf16_f32 v181, |v194|, |v195|
    v_mfma_f32_16x16x32_bf16 v[196:199], a[48:51], v[128:131], v[196:199]
    v_cvt_pk_bf16_f32 v150, v204, v205
    v_cvt_pk_bf16_f32 v151, v206, v207
    v_mfma_f32_16x16x32_bf16 v[192:195], a[64:67], v[128:131], v[112:115]
    v_mul_f32_dpp v204, v48, v16 row_newbcast:9 row_mask:0xf bank_mask:0xf
    v_mul_f32_dpp v205, v52, v20 row_newbcast:9 row_mask:0xf bank_mask:0xf
    v_mfma_f32_16x16x32_bf16 v[192:195], a[68:71], v[132:135], v[192:195]
    v_mul_f32_dpp v206, v49, v17 row_newbcast:9 row_mask:0xf bank_mask:0xf
    v_mul_f32_dpp v207, v53, v21 row_newbcast:9 row_mask:0xf bank_mask:0xf
    v_mfma_f32_16x16x32_bf16 v[192:195], a[72:75], v[136:139], v[192:195]
    v_cvt_pk_bf16_f32 v182, |v196|, |v197|
    v_cvt_pk_bf16_f32 v183, |v198|, |v199|
    v_mfma_f32_16x16x32_bf16 v[192:195], a[76:79], v[140:143], v[192:195]
    v_cvt_pk_bf16_f32 v152, v204, v205
    v_cvt_pk_bf16_f32 v153, v206, v207
    v_mfma_f32_16x16x32_bf16 v[196:199], a[92:95], v[140:143], v[116:119]
    v_mul_f32_dpp v204, v50, v18 row_newbcast:9 row_mask:0xf bank_mask:0xf
    v_mul_f32_dpp v205, v54, v22 row_newbcast:9 row_mask:0xf bank_mask:0xf
    v_mfma_f32_16x16x32_bf16 v[196:199], a[88:91], v[136:139], v[196:199]
    v_mul_f32_dpp v206, v51, v19 row_newbcast:9 row_mask:0xf bank_mask:0xf
    v_mul_f32_dpp v207, v55, v23 row_newbcast:9 row_mask:0xf bank_mask:0xf
    v_mfma_f32_16x16x32_bf16 v[196:199], a[84:87], v[132:135], v[196:199]
    v_cvt_pk_bf16_f32 v184, |v192|, |v193|
    v_cvt_pk_bf16_f32 v185, |v194|, |v195|
    v_mfma_f32_16x16x32_bf16 v[196:199], a[80:83], v[128:131], v[196:199]
    v_cvt_pk_bf16_f32 v154, v204, v205
    v_cvt_pk_bf16_f32 v155, v206, v207
    v_mfma_f32_16x16x32_bf16 v[192:195], a[96:99], v[128:131], v[120:123]
    v_mul_f32_dpp v204, v56, v24 row_newbcast:9 row_mask:0xf bank_mask:0xf
    v_mul_f32_dpp v205, v60, v28 row_newbcast:9 row_mask:0xf bank_mask:0xf
    v_mfma_f32_16x16x32_bf16 v[192:195], a[100:103], v[132:135], v[192:195]
    v_mul_f32_dpp v206, v57, v25 row_newbcast:9 row_mask:0xf bank_mask:0xf
    v_mul_f32_dpp v207, v61, v29 row_newbcast:9 row_mask:0xf bank_mask:0xf
    v_mfma_f32_16x16x32_bf16 v[192:195], a[104:107], v[136:139], v[192:195]
    v_cvt_pk_bf16_f32 v186, |v196|, |v197|
    v_cvt_pk_bf16_f32 v187, |v198|, |v199|
    v_mfma_f32_16x16x32_bf16 v[192:195], a[108:111], v[140:143], v[192:195]
    v_cvt_pk_bf16_f32 v156, v204, v205
    v_cvt_pk_bf16_f32 v157, v206, v207
    v_mfma_f32_16x16x32_bf16 v[196:199], a[124:127], v[140:143], v[124:127]
    v_mul_f32_dpp v204, v58, v26 row_newbcast:9 row_mask:0xf bank_mask:0xf
    v_mul_f32_dpp v205, v62, v30 row_newbcast:9 row_mask:0xf bank_mask:0xf
    v_mfma_f32_16x16x32_bf16 v[196:199], a[120:123], v[136:139], v[196:199]
    v_mul_f32_dpp v206, v59, v27 row_newbcast:9 row_mask:0xf bank_mask:0xf
    v_mul_f32_dpp v207, v63, v31 row_newbcast:9 row_mask:0xf bank_mask:0xf
    v_mfma_f32_16x16x32_bf16 v[196:199], a[116:119], v[132:135], v[196:199]
    v_cvt_pk_bf16_f32 v188, |v192|, |v193|
    v_cvt_pk_bf16_f32 v189, |v194|, |v195|
    v_mfma_f32_16x16x32_bf16 v[196:199], a[112:115], v[128:131], v[196:199]
    v_cvt_pk_bf16_f32 v158, v204, v205
    v_cvt_pk_bf16_f32 v159, v206, v207
    v_mfma_f32_16x16x32_bf16 v[192:195], a[0:3], v[144:147], v[96:99]
    v_mul_f32_dpp v204, v32, v0 row_newbcast:7 row_mask:0xf bank_mask:0xf
    v_mul_f32_dpp v205, v36, v4 row_newbcast:7 row_mask:0xf bank_mask:0xf
    v_mfma_f32_16x16x32_bf16 v[192:195], a[4:7], v[148:151], v[192:195]
    v_mul_f32_dpp v206, v33, v1 row_newbcast:7 row_mask:0xf bank_mask:0xf
    v_mul_f32_dpp v207, v37, v5 row_newbcast:7 row_mask:0xf bank_mask:0xf
    v_mfma_f32_16x16x32_bf16 v[192:195], a[8:11], v[152:155], v[192:195]
    v_cvt_pk_bf16_f32 v190, |v196|, |v197|
    v_cvt_pk_bf16_f32 v191, |v198|, |v199|
    v_mfma_f32_16x16x32_bf16 v[192:195], a[12:15], v[156:159], v[192:195]
    s_waitcnt vmcnt(3)
    v_cvt_pk_bf16_f32 v128, v204, v205
    v_cvt_pk_bf16_f32 v129, v206, v207
    v_smfmac_f32_16x16x64_bf16 v[200:203], a[136:139], v[176:183], v242
    v_lshlrev_b32 v72, 16, v76
    v_smfmac_f32_16x16x64_bf16 v[200:203], a[140:143], v[184:191], v242
    v_and_b32 v76, s41, v76
    v_smfmac_f32_16x16x64_bf16 v[200:203], a[144:147], v[144:151], v242
    v_lshlrev_b32 v73, 16, v77
    v_smfmac_f32_16x16x64_bf16 v[200:203], a[148:151], v[152:159], v242
    v_and_b32 v77, s41, v77
    v_mfma_f32_16x16x32_bf16 v[196:199], a[28:31], v[156:159], v[100:103]
    v_mul_f32_dpp v204, v34, v2 row_newbcast:7 row_mask:0xf bank_mask:0xf
    v_mul_f32_dpp v205, v38, v6 row_newbcast:7 row_mask:0xf bank_mask:0xf
    v_mfma_f32_16x16x32_bf16 v[196:199], a[24:27], v[152:155], v[196:199]
    v_mul_f32_dpp v206, v35, v3 row_newbcast:7 row_mask:0xf bank_mask:0xf
    v_mul_f32_dpp v207, v39, v7 row_newbcast:7 row_mask:0xf bank_mask:0xf
    v_mfma_f32_16x16x32_bf16 v[196:199], a[20:23], v[148:151], v[196:199]
    v_cvt_pk_bf16_f32 v176, |v192|, |v193|
    v_cvt_pk_bf16_f32 v177, |v194|, |v195|
    v_mfma_f32_16x16x32_bf16 v[196:199], a[16:19], v[144:147], v[196:199]
    v_cvt_pk_bf16_f32 v130, v204, v205
    v_cvt_pk_bf16_f32 v131, v206, v207
    v_mfma_f32_16x16x32_bf16 v[192:195], a[32:35], v[144:147], v[104:107]
    v_mul_f32_dpp v204, v40, v8 row_newbcast:7 row_mask:0xf bank_mask:0xf
    v_mul_f32_dpp v205, v44, v12 row_newbcast:7 row_mask:0xf bank_mask:0xf
    v_mfma_f32_16x16x32_bf16 v[192:195], a[36:39], v[148:151], v[192:195]
    v_mul_f32_dpp v206, v41, v9 row_newbcast:7 row_mask:0xf bank_mask:0xf
    v_mul_f32_dpp v207, v45, v13 row_newbcast:7 row_mask:0xf bank_mask:0xf
    v_mfma_f32_16x16x32_bf16 v[192:195], a[40:43], v[152:155], v[192:195]
    v_cvt_pk_bf16_f32 v178, |v196|, |v197|
    v_cvt_pk_bf16_f32 v179, |v198|, |v199|
    v_mfma_f32_16x16x32_bf16 v[192:195], a[44:47], v[156:159], v[192:195]
    v_cvt_pk_bf16_f32 v132, v204, v205
    v_cvt_pk_bf16_f32 v133, v206, v207
    v_mfma_f32_16x16x32_bf16 v[196:199], a[60:63], v[156:159], v[108:111]
    v_mul_f32_dpp v204, v42, v10 row_newbcast:7 row_mask:0xf bank_mask:0xf
    v_mul_f32_dpp v205, v46, v14 row_newbcast:7 row_mask:0xf bank_mask:0xf
    v_mfma_f32_16x16x32_bf16 v[196:199], a[56:59], v[152:155], v[196:199]
    v_mul_f32_dpp v206, v43, v11 row_newbcast:7 row_mask:0xf bank_mask:0xf
    v_mul_f32_dpp v207, v47, v15 row_newbcast:7 row_mask:0xf bank_mask:0xf
    v_mfma_f32_16x16x32_bf16 v[196:199], a[52:55], v[148:151], v[196:199]
    v_cvt_pk_bf16_f32 v180, |v192|, |v193|
    v_cvt_pk_bf16_f32 v181, |v194|, |v195|
    v_mfma_f32_16x16x32_bf16 v[196:199], a[48:51], v[144:147], v[196:199]
    v_cvt_pk_bf16_f32 v134, v204, v205
    v_cvt_pk_bf16_f32 v135, v206, v207
    v_mfma_f32_16x16x32_bf16 v[192:195], a[64:67], v[144:147], v[112:115]
    v_mul_f32_dpp v204, v48, v16 row_newbcast:7 row_mask:0xf bank_mask:0xf
    v_mul_f32_dpp v205, v52, v20 row_newbcast:7 row_mask:0xf bank_mask:0xf
    v_mfma_f32_16x16x32_bf16 v[192:195], a[68:71], v[148:151], v[192:195]
    v_mul_f32_dpp v206, v49, v17 row_newbcast:7 row_mask:0xf bank_mask:0xf
    v_mul_f32_dpp v207, v53, v21 row_newbcast:7 row_mask:0xf bank_mask:0xf
    v_mfma_f32_16x16x32_bf16 v[192:195], a[72:75], v[152:155], v[192:195]
    v_cvt_pk_bf16_f32 v182, |v196|, |v197|
    v_cvt_pk_bf16_f32 v183, |v198|, |v199|
    v_mfma_f32_16x16x32_bf16 v[192:195], a[76:79], v[156:159], v[192:195]
    v_cvt_pk_bf16_f32 v136, v204, v205
    v_cvt_pk_bf16_f32 v137, v206, v207
    v_mfma_f32_16x16x32_bf16 v[196:199], a[92:95], v[156:159], v[116:119]
    v_mul_f32_dpp v204, v50, v18 row_newbcast:7 row_mask:0xf bank_mask:0xf
    v_mul_f32_dpp v205, v54, v22 row_newbcast:7 row_mask:0xf bank_mask:0xf
    v_mfma_f32_16x16x32_bf16 v[196:199], a[88:91], v[152:155], v[196:199]
    v_mul_f32_dpp v206, v51, v19 row_newbcast:7 row_mask:0xf bank_mask:0xf
    v_mul_f32_dpp v207, v55, v23 row_newbcast:7 row_mask:0xf bank_mask:0xf
    v_mfma_f32_16x16x32_bf16 v[196:199], a[84:87], v[148:151], v[196:199]
    v_cvt_pk_bf16_f32 v184, |v192|, |v193|
    v_cvt_pk_bf16_f32 v185, |v194|, |v195|
    v_mfma_f32_16x16x32_bf16 v[196:199], a[80:83], v[144:147], v[196:199]
    v_cvt_pk_bf16_f32 v138, v204, v205
    v_cvt_pk_bf16_f32 v139, v206, v207
    v_mfma_f32_16x16x32_bf16 v[192:195], a[96:99], v[144:147], v[120:123]
    v_mul_f32_dpp v204, v56, v24 row_newbcast:7 row_mask:0xf bank_mask:0xf
    v_mul_f32_dpp v205, v60, v28 row_newbcast:7 row_mask:0xf bank_mask:0xf
    v_mfma_f32_16x16x32_bf16 v[192:195], a[100:103], v[148:151], v[192:195]
    v_mul_f32_dpp v206, v57, v25 row_newbcast:7 row_mask:0xf bank_mask:0xf
    v_mul_f32_dpp v207, v61, v29 row_newbcast:7 row_mask:0xf bank_mask:0xf
    v_mfma_f32_16x16x32_bf16 v[192:195], a[104:107], v[152:155], v[192:195]
    v_cvt_pk_bf16_f32 v186, |v196|, |v197|
    v_cvt_pk_bf16_f32 v187, |v198|, |v199|
    v_mfma_f32_16x16x32_bf16 v[192:195], a[108:111], v[156:159], v[192:195]
    v_cvt_pk_bf16_f32 v140, v204, v205
    v_cvt_pk_bf16_f32 v141, v206, v207
    v_mfma_f32_16x16x32_bf16 v[196:199], a[124:127], v[156:159], v[124:127]
    v_mul_f32_dpp v204, v58, v26 row_newbcast:7 row_mask:0xf bank_mask:0xf
    v_mul_f32_dpp v205, v62, v30 row_newbcast:7 row_mask:0xf bank_mask:0xf
    v_mfma_f32_16x16x32_bf16 v[196:199], a[120:123], v[152:155], v[196:199]
    v_mul_f32_dpp v206, v59, v27 row_newbcast:7 row_mask:0xf bank_mask:0xf
    v_mul_f32_dpp v207, v63, v31 row_newbcast:7 row_mask:0xf bank_mask:0xf
    v_mfma_f32_16x16x32_bf16 v[196:199], a[116:119], v[148:151], v[196:199]
    v_cvt_pk_bf16_f32 v188, |v192|, |v193|
    v_cvt_pk_bf16_f32 v189, |v194|, |v195|
    v_mfma_f32_16x16x32_bf16 v[196:199], a[112:115], v[144:147], v[196:199]
    v_cvt_pk_bf16_f32 v142, v204, v205
    v_cvt_pk_bf16_f32 v143, v206, v207
    v_mfma_f32_16x16x32_bf16 v[192:195], a[0:3], v[128:131], v[96:99]
    v_mul_f32_dpp v204, v32, v0 row_newbcast:11 row_mask:0xf bank_mask:0xf
    v_mul_f32_dpp v205, v36, v4 row_newbcast:11 row_mask:0xf bank_mask:0xf
    v_mfma_f32_16x16x32_bf16 v[192:195], a[4:7], v[132:135], v[192:195]
    v_mul_f32_dpp v206, v33, v1 row_newbcast:11 row_mask:0xf bank_mask:0xf
    v_mul_f32_dpp v207, v37, v5 row_newbcast:11 row_mask:0xf bank_mask:0xf
    v_mfma_f32_16x16x32_bf16 v[192:195], a[8:11], v[136:139], v[192:195]
    v_cvt_pk_bf16_f32 v190, |v196|, |v197|
    v_cvt_pk_bf16_f32 v191, |v198|, |v199|
    v_mfma_f32_16x16x32_bf16 v[192:195], a[12:15], v[140:143], v[192:195]
    s_waitcnt vmcnt(0)
    v_cvt_pk_bf16_f32 v144, v204, v205
    v_cvt_pk_bf16_f32 v145, v206, v207
    v_smfmac_f32_16x16x64_bf16 v[200:203], a[152:155], v[176:183], v242
    v_lshlrev_b32 v74, 16, v78
    v_smfmac_f32_16x16x64_bf16 v[200:203], a[156:159], v[184:191], v242
    v_and_b32 v78, s41, v78
    v_smfmac_f32_16x16x64_bf16 v[200:203], a[160:163], v[128:135], v242
    v_lshlrev_b32 v75, 16, v79
    v_smfmac_f32_16x16x64_bf16 v[200:203], a[164:167], v[136:143], v242
    v_and_b32 v79, s41, v79
    v_mfma_f32_16x16x32_bf16 v[196:199], a[28:31], v[140:143], v[100:103]
    v_mul_f32_dpp v204, v34, v2 row_newbcast:11 row_mask:0xf bank_mask:0xf
    v_mul_f32_dpp v205, v38, v6 row_newbcast:11 row_mask:0xf bank_mask:0xf
    v_mfma_f32_16x16x32_bf16 v[196:199], a[24:27], v[136:139], v[196:199]
    v_mul_f32_dpp v206, v35, v3 row_newbcast:11 row_mask:0xf bank_mask:0xf
    v_mul_f32_dpp v207, v39, v7 row_newbcast:11 row_mask:0xf bank_mask:0xf
    v_mfma_f32_16x16x32_bf16 v[196:199], a[20:23], v[132:135], v[196:199]
    v_cvt_pk_bf16_f32 v176, |v192|, |v193|
    v_cvt_pk_bf16_f32 v177, |v194|, |v195|
    v_mfma_f32_16x16x32_bf16 v[196:199], a[16:19], v[128:131], v[196:199]
    v_cvt_pk_bf16_f32 v146, v204, v205
    v_cvt_pk_bf16_f32 v147, v206, v207
    v_mfma_f32_16x16x32_bf16 v[192:195], a[32:35], v[128:131], v[104:107]
    v_mul_f32_dpp v204, v40, v8 row_newbcast:11 row_mask:0xf bank_mask:0xf
    v_mul_f32_dpp v205, v44, v12 row_newbcast:11 row_mask:0xf bank_mask:0xf
    v_mfma_f32_16x16x32_bf16 v[192:195], a[36:39], v[132:135], v[192:195]
    v_mul_f32_dpp v206, v41, v9 row_newbcast:11 row_mask:0xf bank_mask:0xf
    v_mul_f32_dpp v207, v45, v13 row_newbcast:11 row_mask:0xf bank_mask:0xf
    v_mfma_f32_16x16x32_bf16 v[192:195], a[40:43], v[136:139], v[192:195]
    v_cvt_pk_bf16_f32 v178, |v196|, |v197|
    v_cvt_pk_bf16_f32 v179, |v198|, |v199|
    v_mfma_f32_16x16x32_bf16 v[192:195], a[44:47], v[140:143], v[192:195]
    v_cvt_pk_bf16_f32 v148, v204, v205
    v_cvt_pk_bf16_f32 v149, v206, v207
    v_mfma_f32_16x16x32_bf16 v[196:199], a[60:63], v[140:143], v[108:111]
    v_mul_f32_dpp v204, v42, v10 row_newbcast:11 row_mask:0xf bank_mask:0xf
    v_mul_f32_dpp v205, v46, v14 row_newbcast:11 row_mask:0xf bank_mask:0xf
    v_mfma_f32_16x16x32_bf16 v[196:199], a[56:59], v[136:139], v[196:199]
    v_mul_f32_dpp v206, v43, v11 row_newbcast:11 row_mask:0xf bank_mask:0xf
    v_mul_f32_dpp v207, v47, v15 row_newbcast:11 row_mask:0xf bank_mask:0xf
    v_mfma_f32_16x16x32_bf16 v[196:199], a[52:55], v[132:135], v[196:199]
    v_cvt_pk_bf16_f32 v180, |v192|, |v193|
    v_cvt_pk_bf16_f32 v181, |v194|, |v195|
    v_mfma_f32_16x16x32_bf16 v[196:199], a[48:51], v[128:131], v[196:199]
    v_cvt_pk_bf16_f32 v150, v204, v205
    v_cvt_pk_bf16_f32 v151, v206, v207
    v_lshlrev_b32 v80, 16, v84
    v_and_b32 v84, s41, v84
    v_lshlrev_b32 v81, 16, v85
    v_and_b32 v85, s41, v85
    v_lshlrev_b32 v82, 16, v86
    v_and_b32 v86, s41, v86
    v_lshlrev_b32 v83, 16, v87
    v_and_b32 v87, s41, v87
    v_lshl_add_u32 v240, v240, 8, v246
    v_mfma_f32_16x16x32_bf16 v[192:195], a[64:67], v[128:131], v[112:115]
    v_mul_f32_dpp v204, v48, v16 row_newbcast:11 row_mask:0xf bank_mask:0xf
    v_mul_f32_dpp v205, v52, v20 row_newbcast:11 row_mask:0xf bank_mask:0xf
    v_mfma_f32_16x16x32_bf16 v[192:195], a[68:71], v[132:135], v[192:195]
    v_mul_f32_dpp v206, v49, v17 row_newbcast:11 row_mask:0xf bank_mask:0xf
    v_mul_f32_dpp v207, v53, v21 row_newbcast:11 row_mask:0xf bank_mask:0xf
    v_mfma_f32_16x16x32_bf16 v[192:195], a[72:75], v[136:139], v[192:195]
    v_cvt_pk_bf16_f32 v182, |v196|, |v197|
    v_cvt_pk_bf16_f32 v183, |v198|, |v199|
    v_mfma_f32_16x16x32_bf16 v[192:195], a[76:79], v[140:143], v[192:195]
    v_cvt_pk_bf16_f32 v152, v204, v205
    v_cvt_pk_bf16_f32 v153, v206, v207
    v_mfma_f32_16x16x32_bf16 v[196:199], a[92:95], v[140:143], v[116:119]
    v_mul_f32_dpp v204, v50, v18 row_newbcast:11 row_mask:0xf bank_mask:0xf
    v_mul_f32_dpp v205, v54, v22 row_newbcast:11 row_mask:0xf bank_mask:0xf
    v_mfma_f32_16x16x32_bf16 v[196:199], a[88:91], v[136:139], v[196:199]
    v_mul_f32_dpp v206, v51, v19 row_newbcast:11 row_mask:0xf bank_mask:0xf
    v_mul_f32_dpp v207, v55, v23 row_newbcast:11 row_mask:0xf bank_mask:0xf
    v_mfma_f32_16x16x32_bf16 v[196:199], a[84:87], v[132:135], v[196:199]
    v_cvt_pk_bf16_f32 v184, |v192|, |v193|
    v_cvt_pk_bf16_f32 v185, |v194|, |v195|
    v_mfma_f32_16x16x32_bf16 v[196:199], a[80:83], v[128:131], v[196:199]
    v_cvt_pk_bf16_f32 v154, v204, v205
    v_cvt_pk_bf16_f32 v155, v206, v207
    v_mfma_f32_16x16x32_bf16 v[192:195], a[96:99], v[128:131], v[120:123]
    v_mul_f32_dpp v204, v56, v24 row_newbcast:11 row_mask:0xf bank_mask:0xf
    v_mul_f32_dpp v205, v60, v28 row_newbcast:11 row_mask:0xf bank_mask:0xf
    v_mfma_f32_16x16x32_bf16 v[192:195], a[100:103], v[132:135], v[192:195]
    v_mul_f32_dpp v206, v57, v25 row_newbcast:11 row_mask:0xf bank_mask:0xf
    v_mul_f32_dpp v207, v61, v29 row_newbcast:11 row_mask:0xf bank_mask:0xf
    v_mfma_f32_16x16x32_bf16 v[192:195], a[104:107], v[136:139], v[192:195]
    v_cvt_pk_bf16_f32 v186, |v196|, |v197|
    v_cvt_pk_bf16_f32 v187, |v198|, |v199|
    v_mfma_f32_16x16x32_bf16 v[192:195], a[108:111], v[140:143], v[192:195]
    v_cvt_pk_bf16_f32 v156, v204, v205
    v_cvt_pk_bf16_f32 v157, v206, v207
    v_mfma_f32_16x16x32_bf16 v[196:199], a[124:127], v[140:143], v[124:127]
    v_mul_f32_dpp v204, v58, v26 row_newbcast:11 row_mask:0xf bank_mask:0xf
    v_mul_f32_dpp v205, v62, v30 row_newbcast:11 row_mask:0xf bank_mask:0xf
    v_mfma_f32_16x16x32_bf16 v[196:199], a[120:123], v[136:139], v[196:199]
    v_mul_f32_dpp v206, v59, v27 row_newbcast:11 row_mask:0xf bank_mask:0xf
    v_mul_f32_dpp v207, v63, v31 row_newbcast:11 row_mask:0xf bank_mask:0xf
    v_mfma_f32_16x16x32_bf16 v[196:199], a[116:119], v[132:135], v[196:199]
    v_cvt_pk_bf16_f32 v188, |v192|, |v193|
    v_cvt_pk_bf16_f32 v189, |v194|, |v195|
    v_mfma_f32_16x16x32_bf16 v[196:199], a[112:115], v[128:131], v[196:199]
    v_cvt_pk_bf16_f32 v158, v204, v205
    v_cvt_pk_bf16_f32 v159, v206, v207
    v_mfma_f32_16x16x32_bf16 v[192:195], a[0:3], v[144:147], v[96:99]
    v_mul_f32_dpp v204, v32, v0 row_newbcast:6 row_mask:0xf bank_mask:0xf
    v_mul_f32_dpp v205, v36, v4 row_newbcast:6 row_mask:0xf bank_mask:0xf
    v_mfma_f32_16x16x32_bf16 v[192:195], a[4:7], v[148:151], v[192:195]
    v_mul_f32_dpp v206, v33, v1 row_newbcast:6 row_mask:0xf bank_mask:0xf
    v_mul_f32_dpp v207, v37, v5 row_newbcast:6 row_mask:0xf bank_mask:0xf
    v_mfma_f32_16x16x32_bf16 v[192:195], a[8:11], v[152:155], v[192:195]
    v_cvt_pk_bf16_f32 v190, |v196|, |v197|
    v_cvt_pk_bf16_f32 v191, |v198|, |v199|
    v_mfma_f32_16x16x32_bf16 v[192:195], a[12:15], v[156:159], v[192:195]
    v_cvt_pk_bf16_f32 v128, v204, v205
    v_cvt_pk_bf16_f32 v129, v206, v207
    v_smfmac_f32_16x16x64_bf16 v[200:203], a[168:171], v[176:183], v242
    v_lshlrev_b32 v88, 16, v92
    v_smfmac_f32_16x16x64_bf16 v[200:203], a[172:175], v[184:191], v242
    v_and_b32 v92, s41, v92
    v_smfmac_f32_16x16x64_bf16 v[200:203], a[176:179], v[144:151], v242
    v_lshlrev_b32 v89, 16, v93
    v_smfmac_f32_16x16x64_bf16 v[200:203], a[180:183], v[152:159], v242
    v_and_b32 v93, s41, v93
    v_mfma_f32_16x16x32_bf16 v[196:199], a[28:31], v[156:159], v[100:103]
    v_mul_f32_dpp v204, v34, v2 row_newbcast:6 row_mask:0xf bank_mask:0xf
    v_mul_f32_dpp v205, v38, v6 row_newbcast:6 row_mask:0xf bank_mask:0xf
    v_mfma_f32_16x16x32_bf16 v[196:199], a[24:27], v[152:155], v[196:199]
    v_mul_f32_dpp v206, v35, v3 row_newbcast:6 row_mask:0xf bank_mask:0xf
    v_mul_f32_dpp v207, v39, v7 row_newbcast:6 row_mask:0xf bank_mask:0xf
    v_mfma_f32_16x16x32_bf16 v[196:199], a[20:23], v[148:151], v[196:199]
    v_cvt_pk_bf16_f32 v176, |v192|, |v193|
    v_cvt_pk_bf16_f32 v177, |v194|, |v195|
    v_mfma_f32_16x16x32_bf16 v[196:199], a[16:19], v[144:147], v[196:199]
    buffer_load_dwordx4 v[4:7], v238, s[24:27], 0 offen offset:0
    v_cvt_pk_bf16_f32 v130, v204, v205
    v_cvt_pk_bf16_f32 v131, v206, v207
    v_mfma_f32_16x16x32_bf16 v[192:195], a[32:35], v[144:147], v[104:107]
    v_mul_f32_dpp v204, v40, v8 row_newbcast:6 row_mask:0xf bank_mask:0xf
    v_mul_f32_dpp v205, v44, v12 row_newbcast:6 row_mask:0xf bank_mask:0xf
    v_mfma_f32_16x16x32_bf16 v[192:195], a[36:39], v[148:151], v[192:195]
    v_mul_f32_dpp v206, v41, v9 row_newbcast:6 row_mask:0xf bank_mask:0xf
    v_mul_f32_dpp v207, v45, v13 row_newbcast:6 row_mask:0xf bank_mask:0xf
    v_mfma_f32_16x16x32_bf16 v[192:195], a[40:43], v[152:155], v[192:195]
    v_cvt_pk_bf16_f32 v178, |v196|, |v197|
    v_cvt_pk_bf16_f32 v179, |v198|, |v199|
    v_mfma_f32_16x16x32_bf16 v[192:195], a[44:47], v[156:159], v[192:195]
    v_cvt_pk_bf16_f32 v132, v204, v205
    v_cvt_pk_bf16_f32 v133, v206, v207
    v_mfma_f32_16x16x32_bf16 v[196:199], a[60:63], v[156:159], v[108:111]
    v_mul_f32_dpp v204, v42, v10 row_newbcast:6 row_mask:0xf bank_mask:0xf
    v_mul_f32_dpp v205, v46, v14 row_newbcast:6 row_mask:0xf bank_mask:0xf
    v_mfma_f32_16x16x32_bf16 v[196:199], a[56:59], v[152:155], v[196:199]
    v_mul_f32_dpp v206, v43, v11 row_newbcast:6 row_mask:0xf bank_mask:0xf
    v_mul_f32_dpp v207, v47, v15 row_newbcast:6 row_mask:0xf bank_mask:0xf
    v_mfma_f32_16x16x32_bf16 v[196:199], a[52:55], v[148:151], v[196:199]
    v_cvt_pk_bf16_f32 v180, |v192|, |v193|
    v_cvt_pk_bf16_f32 v181, |v194|, |v195|
    v_mfma_f32_16x16x32_bf16 v[196:199], a[48:51], v[144:147], v[196:199]
    buffer_load_dwordx4 v[12:15], v238, s[24:27], 0 offen offset:16
    v_cvt_pk_bf16_f32 v134, v204, v205
    v_cvt_pk_bf16_f32 v135, v206, v207
    v_mfma_f32_16x16x32_bf16 v[192:195], a[64:67], v[144:147], v[112:115]
    v_mul_f32_dpp v204, v48, v16 row_newbcast:6 row_mask:0xf bank_mask:0xf
    v_mul_f32_dpp v205, v52, v20 row_newbcast:6 row_mask:0xf bank_mask:0xf
    v_mfma_f32_16x16x32_bf16 v[192:195], a[68:71], v[148:151], v[192:195]
    v_mul_f32_dpp v206, v49, v17 row_newbcast:6 row_mask:0xf bank_mask:0xf
    v_mul_f32_dpp v207, v53, v21 row_newbcast:6 row_mask:0xf bank_mask:0xf
    v_mfma_f32_16x16x32_bf16 v[192:195], a[72:75], v[152:155], v[192:195]
    v_cvt_pk_bf16_f32 v182, |v196|, |v197|
    v_cvt_pk_bf16_f32 v183, |v198|, |v199|
    v_mfma_f32_16x16x32_bf16 v[192:195], a[76:79], v[156:159], v[192:195]
    v_cvt_pk_bf16_f32 v136, v204, v205
    v_cvt_pk_bf16_f32 v137, v206, v207
    v_mfma_f32_16x16x32_bf16 v[196:199], a[92:95], v[156:159], v[116:119]
    v_mul_f32_dpp v204, v50, v18 row_newbcast:6 row_mask:0xf bank_mask:0xf
    v_mul_f32_dpp v205, v54, v22 row_newbcast:6 row_mask:0xf bank_mask:0xf
    v_mfma_f32_16x16x32_bf16 v[196:199], a[88:91], v[152:155], v[196:199]
    v_mul_f32_dpp v206, v51, v19 row_newbcast:6 row_mask:0xf bank_mask:0xf
    v_mul_f32_dpp v207, v55, v23 row_newbcast:6 row_mask:0xf bank_mask:0xf
    v_mfma_f32_16x16x32_bf16 v[196:199], a[84:87], v[148:151], v[196:199]
    v_cvt_pk_bf16_f32 v184, |v192|, |v193|
    v_cvt_pk_bf16_f32 v185, |v194|, |v195|
    v_mfma_f32_16x16x32_bf16 v[196:199], a[80:83], v[144:147], v[196:199]
    buffer_load_dwordx4 v[20:23], v238, s[24:27], 0 offen offset:32
    v_cvt_pk_bf16_f32 v138, v204, v205
    v_cvt_pk_bf16_f32 v139, v206, v207
    v_mfma_f32_16x16x32_bf16 v[192:195], a[96:99], v[144:147], v[120:123]
    v_mul_f32_dpp v204, v56, v24 row_newbcast:6 row_mask:0xf bank_mask:0xf
    v_mul_f32_dpp v205, v60, v28 row_newbcast:6 row_mask:0xf bank_mask:0xf
    v_mfma_f32_16x16x32_bf16 v[192:195], a[100:103], v[148:151], v[192:195]
    v_mul_f32_dpp v206, v57, v25 row_newbcast:6 row_mask:0xf bank_mask:0xf
    v_mul_f32_dpp v207, v61, v29 row_newbcast:6 row_mask:0xf bank_mask:0xf
    v_mfma_f32_16x16x32_bf16 v[192:195], a[104:107], v[152:155], v[192:195]
    v_cvt_pk_bf16_f32 v186, |v196|, |v197|
    v_cvt_pk_bf16_f32 v187, |v198|, |v199|
    v_mfma_f32_16x16x32_bf16 v[192:195], a[108:111], v[156:159], v[192:195]
    v_cvt_pk_bf16_f32 v140, v204, v205
    v_cvt_pk_bf16_f32 v141, v206, v207
    v_mfma_f32_16x16x32_bf16 v[196:199], a[124:127], v[156:159], v[124:127]
    v_mul_f32_dpp v204, v58, v26 row_newbcast:6 row_mask:0xf bank_mask:0xf
    v_mul_f32_dpp v205, v62, v30 row_newbcast:6 row_mask:0xf bank_mask:0xf
    v_mfma_f32_16x16x32_bf16 v[196:199], a[120:123], v[152:155], v[196:199]
    v_mul_f32_dpp v206, v59, v27 row_newbcast:6 row_mask:0xf bank_mask:0xf
    v_mul_f32_dpp v207, v63, v31 row_newbcast:6 row_mask:0xf bank_mask:0xf
    v_mfma_f32_16x16x32_bf16 v[196:199], a[116:119], v[148:151], v[196:199]
    v_cvt_pk_bf16_f32 v188, |v192|, |v193|
    v_cvt_pk_bf16_f32 v189, |v194|, |v195|
    v_mfma_f32_16x16x32_bf16 v[196:199], a[112:115], v[144:147], v[196:199]
    buffer_load_dwordx4 v[28:31], v238, s[24:27], 0 offen offset:48
    v_cvt_pk_bf16_f32 v142, v204, v205
    v_cvt_pk_bf16_f32 v143, v206, v207
    v_mfma_f32_16x16x32_bf16 v[192:195], a[0:3], v[128:131], v[96:99]
    v_mul_f32 v204, v32, v64
    v_mul_f32 v205, v36, v68
    v_mfma_f32_16x16x32_bf16 v[192:195], a[4:7], v[132:135], v[192:195]
    v_mul_f32 v206, v33, v65
    v_mul_f32 v207, v37, v69
    v_mfma_f32_16x16x32_bf16 v[192:195], a[8:11], v[136:139], v[192:195]
    v_cvt_pk_bf16_f32 v190, |v196|, |v197|
    v_cvt_pk_bf16_f32 v191, |v198|, |v199|
    v_mfma_f32_16x16x32_bf16 v[192:195], a[12:15], v[140:143], v[192:195]
    v_cvt_pk_bf16_f32 v144, v204, v205
    v_cvt_pk_bf16_f32 v145, v206, v207
    v_smfmac_f32_16x16x64_bf16 v[200:203], a[184:187], v[176:183], v242
    v_lshlrev_b32 v90, 16, v94
    v_smfmac_f32_16x16x64_bf16 v[200:203], a[188:191], v[184:191], v242
    v_and_b32 v94, s41, v94
    v_mfma_f32_16x16x32_bf16 v[196:199], a[28:31], v[140:143], v[100:103]
    v_mul_f32 v204, v34, v66
    v_mul_f32 v205, v38, v70
    v_mfma_f32_16x16x32_bf16 v[196:199], a[24:27], v[136:139], v[196:199]
    v_mul_f32 v206, v35, v67
    v_mul_f32 v207, v39, v71
    v_mfma_f32_16x16x32_bf16 v[196:199], a[20:23], v[132:135], v[196:199]
    v_cvt_pk_bf16_f32 v176, |v192|, |v193|
    v_cvt_pk_bf16_f32 v177, |v194|, |v195|
    v_mfma_f32_16x16x32_bf16 v[196:199], a[16:19], v[128:131], v[196:199]
    v_add_f32 v215, v200, v201
    v_add_f32 v220, v202, v203
    v_mov_b64 v[200:201], 0
    v_mov_b64 v[202:203], 0
    v_cvt_pk_bf16_f32 v146, v204, v205
    v_cvt_pk_bf16_f32 v147, v206, v207
    v_smfmac_f32_16x16x64_bf16 v[200:203], a[128:131], v[128:135], v242
    v_lshlrev_b32 v91, 16, v95
    v_smfmac_f32_16x16x64_bf16 v[200:203], a[132:135], v[136:143], v242
    v_and_b32 v95, s41, v95
    v_mfma_f32_16x16x32_bf16 v[192:195], a[32:35], v[128:131], v[104:107]
    v_mul_f32 v204, v40, v72
    v_mul_f32 v205, v44, v76
    v_mfma_f32_16x16x32_bf16 v[192:195], a[36:39], v[132:135], v[192:195]
    v_mul_f32 v206, v41, v73
    v_mul_f32 v207, v45, v77
    v_mfma_f32_16x16x32_bf16 v[192:195], a[40:43], v[136:139], v[192:195]
    v_cvt_pk_bf16_f32 v178, |v196|, |v197|
    v_cvt_pk_bf16_f32 v179, |v198|, |v199|
    v_mfma_f32_16x16x32_bf16 v[192:195], a[44:47], v[140:143], v[192:195]
    v_cvt_pk_bf16_f32 v148, v204, v205
    v_cvt_pk_bf16_f32 v149, v206, v207
    v_mfma_f32_16x16x32_bf16 v[196:199], a[60:63], v[140:143], v[108:111]
    v_mul_f32 v204, v42, v74
    v_mul_f32 v205, v46, v78
    v_mfma_f32_16x16x32_bf16 v[196:199], a[56:59], v[136:139], v[196:199]
    v_mul_f32 v206, v43, v75
    v_mul_f32 v207, v47, v79
    v_mfma_f32_16x16x32_bf16 v[196:199], a[52:55], v[132:135], v[196:199]
    v_cvt_pk_bf16_f32 v180, |v192|, |v193|
    v_cvt_pk_bf16_f32 v181, |v194|, |v195|
    v_mfma_f32_16x16x32_bf16 v[196:199], a[48:51], v[128:131], v[196:199]
    v_cvt_pk_bf16_f32 v150, v204, v205
    v_cvt_pk_bf16_f32 v151, v206, v207
    v_mfma_f32_16x16x32_bf16 v[192:195], a[64:67], v[128:131], v[112:115]
    v_mul_f32 v204, v48, v80
    v_mul_f32 v205, v52, v84
    v_mfma_f32_16x16x32_bf16 v[192:195], a[68:71], v[132:135], v[192:195]
    v_mul_f32 v206, v49, v81
    v_mul_f32 v207, v53, v85
    v_mfma_f32_16x16x32_bf16 v[192:195], a[72:75], v[136:139], v[192:195]
    v_cvt_pk_bf16_f32 v182, |v196|, |v197|
    v_cvt_pk_bf16_f32 v183, |v198|, |v199|
    v_mfma_f32_16x16x32_bf16 v[192:195], a[76:79], v[140:143], v[192:195]
    buffer_load_dword v238, v243, s[20:23], s33 offen
    v_cvt_pk_bf16_f32 v152, v204, v205
    v_cvt_pk_bf16_f32 v153, v206, v207
    v_mfma_f32_16x16x32_bf16 v[196:199], a[92:95], v[140:143], v[116:119]
    v_mul_f32 v204, v50, v82
    v_mul_f32 v205, v54, v86
    v_mfma_f32_16x16x32_bf16 v[196:199], a[88:91], v[136:139], v[196:199]
    v_mul_f32 v206, v51, v83
    v_mul_f32 v207, v55, v87
    v_mfma_f32_16x16x32_bf16 v[196:199], a[84:87], v[132:135], v[196:199]
    v_cvt_pk_bf16_f32 v184, |v192|, |v193|
    v_cvt_pk_bf16_f32 v185, |v194|, |v195|
    v_mfma_f32_16x16x32_bf16 v[196:199], a[80:83], v[128:131], v[196:199]
    v_cvt_pk_bf16_f32 v154, v204, v205
    v_cvt_pk_bf16_f32 v155, v206, v207
    v_mfma_f32_16x16x32_bf16 v[192:195], a[96:99], v[128:131], v[120:123]
    v_mul_f32 v204, v56, v88
    v_mul_f32 v205, v60, v92
    v_mfma_f32_16x16x32_bf16 v[192:195], a[100:103], v[132:135], v[192:195]
    v_mul_f32 v206, v57, v89
    v_mul_f32 v207, v61, v93
    v_mfma_f32_16x16x32_bf16 v[192:195], a[104:107], v[136:139], v[192:195]
    v_cvt_pk_bf16_f32 v186, |v196|, |v197|
    v_cvt_pk_bf16_f32 v187, |v198|, |v199|
    v_mfma_f32_16x16x32_bf16 v[192:195], a[108:111], v[140:143], v[192:195]
    v_cvt_pk_bf16_f32 v156, v204, v205
    v_cvt_pk_bf16_f32 v157, v206, v207
    v_mfma_f32_16x16x32_bf16 v[196:199], a[124:127], v[140:143], v[124:127]
    v_mul_f32 v204, v58, v90
    v_mul_f32 v205, v62, v94
    v_mfma_f32_16x16x32_bf16 v[196:199], a[120:123], v[136:139], v[196:199]
    v_mul_f32 v206, v59, v91
    v_mul_f32 v207, v63, v95
    v_mfma_f32_16x16x32_bf16 v[196:199], a[116:119], v[132:135], v[196:199]
    v_cvt_pk_bf16_f32 v188, |v192|, |v193|
    v_cvt_pk_bf16_f32 v189, |v194|, |v195|
    v_mfma_f32_16x16x32_bf16 v[196:199], a[112:115], v[128:131], v[196:199]
    v_cvt_pk_bf16_f32 v158, v204, v205
    v_cvt_pk_bf16_f32 v159, v206, v207
    v_mfma_f32_16x16x32_bf16 v[192:195], a[0:3], v[144:147], v[96:99]
    v_mul_f32_dpp v204, v32, v64 row_ror:15 row_mask:0xf bank_mask:0xf
    v_mul_f32_dpp v205, v36, v68 row_ror:15 row_mask:0xf bank_mask:0xf
    v_mfma_f32_16x16x32_bf16 v[192:195], a[4:7], v[148:151], v[192:195]
    v_mul_f32_dpp v206, v33, v65 row_ror:15 row_mask:0xf bank_mask:0xf
    v_mul_f32_dpp v207, v37, v69 row_ror:15 row_mask:0xf bank_mask:0xf
    v_mfma_f32_16x16x32_bf16 v[192:195], a[8:11], v[152:155], v[192:195]
    v_cvt_pk_bf16_f32 v190, |v196|, |v197|
    v_cvt_pk_bf16_f32 v191, |v198|, |v199|
    v_mfma_f32_16x16x32_bf16 v[192:195], a[12:15], v[156:159], v[192:195]
    s_waitcnt vmcnt(4)
    v_cvt_pk_bf16_f32 v128, v204, v205
    v_cvt_pk_bf16_f32 v129, v206, v207
    v_smfmac_f32_16x16x64_bf16 v[200:203], a[136:139], v[176:183], v242
    v_lshlrev_b32 v0, 16, v4
    v_smfmac_f32_16x16x64_bf16 v[200:203], a[140:143], v[184:191], v242
    v_and_b32 v4, s41, v4
    v_smfmac_f32_16x16x64_bf16 v[200:203], a[144:147], v[144:151], v242
    v_lshlrev_b32 v1, 16, v5
    v_smfmac_f32_16x16x64_bf16 v[200:203], a[148:151], v[152:159], v242
    v_and_b32 v5, s41, v5
    v_mfma_f32_16x16x32_bf16 v[196:199], a[28:31], v[156:159], v[100:103]
    v_mul_f32_dpp v204, v34, v66 row_ror:15 row_mask:0xf bank_mask:0xf
    v_mul_f32_dpp v205, v38, v70 row_ror:15 row_mask:0xf bank_mask:0xf
    v_mfma_f32_16x16x32_bf16 v[196:199], a[24:27], v[152:155], v[196:199]
    v_mul_f32_dpp v206, v35, v67 row_ror:15 row_mask:0xf bank_mask:0xf
    v_mul_f32_dpp v207, v39, v71 row_ror:15 row_mask:0xf bank_mask:0xf
    v_mfma_f32_16x16x32_bf16 v[196:199], a[20:23], v[148:151], v[196:199]
    v_cvt_pk_bf16_f32 v176, |v192|, |v193|
    v_cvt_pk_bf16_f32 v177, |v194|, |v195|
    v_mfma_f32_16x16x32_bf16 v[196:199], a[16:19], v[144:147], v[196:199]
    v_cvt_pk_bf16_f32 v130, v204, v205
    v_cvt_pk_bf16_f32 v131, v206, v207
    v_mfma_f32_16x16x32_bf16 v[192:195], a[32:35], v[144:147], v[104:107]
    v_mul_f32_dpp v204, v40, v72 row_ror:15 row_mask:0xf bank_mask:0xf
    v_mul_f32_dpp v205, v44, v76 row_ror:15 row_mask:0xf bank_mask:0xf
    v_mfma_f32_16x16x32_bf16 v[192:195], a[36:39], v[148:151], v[192:195]
    v_mul_f32_dpp v206, v41, v73 row_ror:15 row_mask:0xf bank_mask:0xf
    v_mul_f32_dpp v207, v45, v77 row_ror:15 row_mask:0xf bank_mask:0xf
    v_mfma_f32_16x16x32_bf16 v[192:195], a[40:43], v[152:155], v[192:195]
    v_cvt_pk_bf16_f32 v178, |v196|, |v197|
    v_cvt_pk_bf16_f32 v179, |v198|, |v199|
    v_mfma_f32_16x16x32_bf16 v[192:195], a[44:47], v[156:159], v[192:195]
    v_cvt_pk_bf16_f32 v132, v204, v205
    v_cvt_pk_bf16_f32 v133, v206, v207
    v_mfma_f32_16x16x32_bf16 v[196:199], a[60:63], v[156:159], v[108:111]
    v_mul_f32_dpp v204, v42, v74 row_ror:15 row_mask:0xf bank_mask:0xf
    v_mul_f32_dpp v205, v46, v78 row_ror:15 row_mask:0xf bank_mask:0xf
    v_mfma_f32_16x16x32_bf16 v[196:199], a[56:59], v[152:155], v[196:199]
    v_mul_f32_dpp v206, v43, v75 row_ror:15 row_mask:0xf bank_mask:0xf
    v_mul_f32_dpp v207, v47, v79 row_ror:15 row_mask:0xf bank_mask:0xf
    v_mfma_f32_16x16x32_bf16 v[196:199], a[52:55], v[148:151], v[196:199]
    v_cvt_pk_bf16_f32 v180, |v192|, |v193|
    v_cvt_pk_bf16_f32 v181, |v194|, |v195|
    v_mfma_f32_16x16x32_bf16 v[196:199], a[48:51], v[144:147], v[196:199]
    v_cvt_pk_bf16_f32 v134, v204, v205
    v_cvt_pk_bf16_f32 v135, v206, v207
    v_mfma_f32_16x16x32_bf16 v[192:195], a[64:67], v[144:147], v[112:115]
    v_mul_f32_dpp v204, v48, v80 row_ror:15 row_mask:0xf bank_mask:0xf
    v_mul_f32_dpp v205, v52, v84 row_ror:15 row_mask:0xf bank_mask:0xf
    v_mfma_f32_16x16x32_bf16 v[192:195], a[68:71], v[148:151], v[192:195]
    v_mul_f32_dpp v206, v49, v81 row_ror:15 row_mask:0xf bank_mask:0xf
    v_mul_f32_dpp v207, v53, v85 row_ror:15 row_mask:0xf bank_mask:0xf
    v_mfma_f32_16x16x32_bf16 v[192:195], a[72:75], v[152:155], v[192:195]
    v_cvt_pk_bf16_f32 v182, |v196|, |v197|
    v_cvt_pk_bf16_f32 v183, |v198|, |v199|
    v_mfma_f32_16x16x32_bf16 v[192:195], a[76:79], v[156:159], v[192:195]
    v_cvt_pk_bf16_f32 v136, v204, v205
    v_cvt_pk_bf16_f32 v137, v206, v207
    v_mfma_f32_16x16x32_bf16 v[196:199], a[92:95], v[156:159], v[116:119]
    v_mul_f32_dpp v204, v50, v82 row_ror:15 row_mask:0xf bank_mask:0xf
    v_mul_f32_dpp v205, v54, v86 row_ror:15 row_mask:0xf bank_mask:0xf
    v_mfma_f32_16x16x32_bf16 v[196:199], a[88:91], v[152:155], v[196:199]
    v_mul_f32_dpp v206, v51, v83 row_ror:15 row_mask:0xf bank_mask:0xf
    v_mul_f32_dpp v207, v55, v87 row_ror:15 row_mask:0xf bank_mask:0xf
    v_mfma_f32_16x16x32_bf16 v[196:199], a[84:87], v[148:151], v[196:199]
    v_cvt_pk_bf16_f32 v184, |v192|, |v193|
    v_cvt_pk_bf16_f32 v185, |v194|, |v195|
    v_mfma_f32_16x16x32_bf16 v[196:199], a[80:83], v[144:147], v[196:199]
    v_cvt_pk_bf16_f32 v138, v204, v205
    v_cvt_pk_bf16_f32 v139, v206, v207
    v_mfma_f32_16x16x32_bf16 v[192:195], a[96:99], v[144:147], v[120:123]
    v_mul_f32_dpp v204, v56, v88 row_ror:15 row_mask:0xf bank_mask:0xf
    v_mul_f32_dpp v205, v60, v92 row_ror:15 row_mask:0xf bank_mask:0xf
    v_mfma_f32_16x16x32_bf16 v[192:195], a[100:103], v[148:151], v[192:195]
    v_mul_f32_dpp v206, v57, v89 row_ror:15 row_mask:0xf bank_mask:0xf
    v_mul_f32_dpp v207, v61, v93 row_ror:15 row_mask:0xf bank_mask:0xf
    v_mfma_f32_16x16x32_bf16 v[192:195], a[104:107], v[152:155], v[192:195]
    v_cvt_pk_bf16_f32 v186, |v196|, |v197|
    v_cvt_pk_bf16_f32 v187, |v198|, |v199|
    v_mfma_f32_16x16x32_bf16 v[192:195], a[108:111], v[156:159], v[192:195]
    v_cvt_pk_bf16_f32 v140, v204, v205
    v_cvt_pk_bf16_f32 v141, v206, v207
    v_mfma_f32_16x16x32_bf16 v[196:199], a[124:127], v[156:159], v[124:127]
    v_mul_f32_dpp v204, v58, v90 row_ror:15 row_mask:0xf bank_mask:0xf
    v_mul_f32_dpp v205, v62, v94 row_ror:15 row_mask:0xf bank_mask:0xf
    v_mfma_f32_16x16x32_bf16 v[196:199], a[120:123], v[152:155], v[196:199]
    v_mul_f32_dpp v206, v59, v91 row_ror:15 row_mask:0xf bank_mask:0xf
    v_mul_f32_dpp v207, v63, v95 row_ror:15 row_mask:0xf bank_mask:0xf
    v_mfma_f32_16x16x32_bf16 v[196:199], a[116:119], v[148:151], v[196:199]
    v_cvt_pk_bf16_f32 v188, |v192|, |v193|
    v_cvt_pk_bf16_f32 v189, |v194|, |v195|
    v_mfma_f32_16x16x32_bf16 v[196:199], a[112:115], v[144:147], v[196:199]
    v_cvt_pk_bf16_f32 v142, v204, v205
    v_cvt_pk_bf16_f32 v143, v206, v207
    v_mfma_f32_16x16x32_bf16 v[192:195], a[0:3], v[128:131], v[96:99]
    v_mul_f32_dpp v204, v32, v64 row_ror:13 row_mask:0xf bank_mask:0xf
    v_mul_f32_dpp v205, v36, v68 row_ror:13 row_mask:0xf bank_mask:0xf
    v_mfma_f32_16x16x32_bf16 v[192:195], a[4:7], v[132:135], v[192:195]
    v_mul_f32_dpp v206, v33, v65 row_ror:13 row_mask:0xf bank_mask:0xf
    v_mul_f32_dpp v207, v37, v69 row_ror:13 row_mask:0xf bank_mask:0xf
    v_mfma_f32_16x16x32_bf16 v[192:195], a[8:11], v[136:139], v[192:195]
    v_cvt_pk_bf16_f32 v190, |v196|, |v197|
    v_cvt_pk_bf16_f32 v191, |v198|, |v199|
    v_mfma_f32_16x16x32_bf16 v[192:195], a[12:15], v[140:143], v[192:195]
    v_cvt_pk_bf16_f32 v144, v204, v205
    v_cvt_pk_bf16_f32 v145, v206, v207
    v_smfmac_f32_16x16x64_bf16 v[200:203], a[152:155], v[176:183], v242
    v_lshlrev_b32 v2, 16, v6
    v_smfmac_f32_16x16x64_bf16 v[200:203], a[156:159], v[184:191], v242
    v_and_b32 v6, s41, v6
    v_smfmac_f32_16x16x64_bf16 v[200:203], a[160:163], v[128:135], v242
    v_lshlrev_b32 v3, 16, v7
    v_smfmac_f32_16x16x64_bf16 v[200:203], a[164:167], v[136:143], v242
    v_and_b32 v7, s41, v7
    v_mfma_f32_16x16x32_bf16 v[196:199], a[28:31], v[140:143], v[100:103]
    v_mul_f32_dpp v204, v34, v66 row_ror:13 row_mask:0xf bank_mask:0xf
    v_mul_f32_dpp v205, v38, v70 row_ror:13 row_mask:0xf bank_mask:0xf
    v_mfma_f32_16x16x32_bf16 v[196:199], a[24:27], v[136:139], v[196:199]
    v_mul_f32_dpp v206, v35, v67 row_ror:13 row_mask:0xf bank_mask:0xf
    v_mul_f32_dpp v207, v39, v71 row_ror:13 row_mask:0xf bank_mask:0xf
    v_mfma_f32_16x16x32_bf16 v[196:199], a[20:23], v[132:135], v[196:199]
    v_cvt_pk_bf16_f32 v176, |v192|, |v193|
    v_cvt_pk_bf16_f32 v177, |v194|, |v195|
    v_mfma_f32_16x16x32_bf16 v[196:199], a[16:19], v[128:131], v[196:199]
    buffer_load_dwordx4 v[36:39], v239, s[24:27], 0 offen offset:0
    v_cvt_pk_bf16_f32 v146, v204, v205
    v_cvt_pk_bf16_f32 v147, v206, v207
    v_mfma_f32_16x16x32_bf16 v[192:195], a[32:35], v[128:131], v[104:107]
    v_mul_f32_dpp v204, v40, v72 row_ror:13 row_mask:0xf bank_mask:0xf
    v_mul_f32_dpp v205, v44, v76 row_ror:13 row_mask:0xf bank_mask:0xf
    v_mfma_f32_16x16x32_bf16 v[192:195], a[36:39], v[132:135], v[192:195]
    v_mul_f32_dpp v206, v41, v73 row_ror:13 row_mask:0xf bank_mask:0xf
    v_mul_f32_dpp v207, v45, v77 row_ror:13 row_mask:0xf bank_mask:0xf
    v_mfma_f32_16x16x32_bf16 v[192:195], a[40:43], v[136:139], v[192:195]
    v_cvt_pk_bf16_f32 v178, |v196|, |v197|
    v_cvt_pk_bf16_f32 v179, |v198|, |v199|
    v_mfma_f32_16x16x32_bf16 v[192:195], a[44:47], v[140:143], v[192:195]
    v_cvt_pk_bf16_f32 v148, v204, v205
    v_cvt_pk_bf16_f32 v149, v206, v207
    v_mfma_f32_16x16x32_bf16 v[196:199], a[60:63], v[140:143], v[108:111]
    v_mul_f32_dpp v204, v42, v74 row_ror:13 row_mask:0xf bank_mask:0xf
    v_mul_f32_dpp v205, v46, v78 row_ror:13 row_mask:0xf bank_mask:0xf
    v_mfma_f32_16x16x32_bf16 v[196:199], a[56:59], v[136:139], v[196:199]
    v_mul_f32_dpp v206, v43, v75 row_ror:13 row_mask:0xf bank_mask:0xf
    v_mul_f32_dpp v207, v47, v79 row_ror:13 row_mask:0xf bank_mask:0xf
    v_mfma_f32_16x16x32_bf16 v[196:199], a[52:55], v[132:135], v[196:199]
    v_cvt_pk_bf16_f32 v180, |v192|, |v193|
    v_cvt_pk_bf16_f32 v181, |v194|, |v195|
    v_mfma_f32_16x16x32_bf16 v[196:199], a[48:51], v[128:131], v[196:199]
    buffer_load_dwordx4 v[44:47], v239, s[24:27], 0 offen offset:16
    v_cvt_pk_bf16_f32 v150, v204, v205
    v_cvt_pk_bf16_f32 v151, v206, v207
    v_mfma_f32_16x16x32_bf16 v[192:195], a[64:67], v[128:131], v[112:115]
    v_mul_f32_dpp v204, v48, v80 row_ror:13 row_mask:0xf bank_mask:0xf
    v_mul_f32_dpp v205, v52, v84 row_ror:13 row_mask:0xf bank_mask:0xf
    v_mfma_f32_16x16x32_bf16 v[192:195], a[68:71], v[132:135], v[192:195]
    v_mul_f32_dpp v206, v49, v81 row_ror:13 row_mask:0xf bank_mask:0xf
    v_mul_f32_dpp v207, v53, v85 row_ror:13 row_mask:0xf bank_mask:0xf
    v_mfma_f32_16x16x32_bf16 v[192:195], a[72:75], v[136:139], v[192:195]
    v_cvt_pk_bf16_f32 v182, |v196|, |v197|
    v_cvt_pk_bf16_f32 v183, |v198|, |v199|
    v_mfma_f32_16x16x32_bf16 v[192:195], a[76:79], v[140:143], v[192:195]
    s_waitcnt vmcnt(5)
    v_cvt_pk_bf16_f32 v152, v204, v205
    v_cvt_pk_bf16_f32 v153, v206, v207
    v_lshlrev_b32 v8, 16, v12
    v_and_b32 v12, s41, v12
    v_lshlrev_b32 v9, 16, v13
    v_and_b32 v13, s41, v13
    v_lshlrev_b32 v10, 16, v14
    v_and_b32 v14, s41, v14
    v_lshlrev_b32 v11, 16, v15
    v_and_b32 v15, s41, v15
    v_mfma_f32_16x16x32_bf16 v[196:199], a[92:95], v[140:143], v[116:119]
    v_mul_f32_dpp v204, v50, v82 row_ror:13 row_mask:0xf bank_mask:0xf
    v_mul_f32_dpp v205, v54, v86 row_ror:13 row_mask:0xf bank_mask:0xf
    v_mfma_f32_16x16x32_bf16 v[196:199], a[88:91], v[136:139], v[196:199]
    v_mul_f32_dpp v206, v51, v83 row_ror:13 row_mask:0xf bank_mask:0xf
    v_mul_f32_dpp v207, v55, v87 row_ror:13 row_mask:0xf bank_mask:0xf
    v_mfma_f32_16x16x32_bf16 v[196:199], a[84:87], v[132:135], v[196:199]
    v_cvt_pk_bf16_f32 v184, |v192|, |v193|
    v_cvt_pk_bf16_f32 v185, |v194|, |v195|
    v_mfma_f32_16x16x32_bf16 v[196:199], a[80:83], v[128:131], v[196:199]
    buffer_load_dwordx4 v[52:55], v239, s[24:27], 0 offen offset:32
    v_cvt_pk_bf16_f32 v154, v204, v205
    v_cvt_pk_bf16_f32 v155, v206, v207
    v_mfma_f32_16x16x32_bf16 v[192:195], a[96:99], v[128:131], v[120:123]
    v_mul_f32_dpp v204, v56, v88 row_ror:13 row_mask:0xf bank_mask:0xf
    v_mul_f32_dpp v205, v60, v92 row_ror:13 row_mask:0xf bank_mask:0xf
    v_mfma_f32_16x16x32_bf16 v[192:195], a[100:103], v[132:135], v[192:195]
    v_mul_f32_dpp v206, v57, v89 row_ror:13 row_mask:0xf bank_mask:0xf
    v_mul_f32_dpp v207, v61, v93 row_ror:13 row_mask:0xf bank_mask:0xf
    v_mfma_f32_16x16x32_bf16 v[192:195], a[104:107], v[136:139], v[192:195]
    v_cvt_pk_bf16_f32 v186, |v196|, |v197|
    v_cvt_pk_bf16_f32 v187, |v198|, |v199|
    v_mfma_f32_16x16x32_bf16 v[192:195], a[108:111], v[140:143], v[192:195]
    s_waitcnt vmcnt(5)
    v_cvt_pk_bf16_f32 v156, v204, v205
    v_cvt_pk_bf16_f32 v157, v206, v207
    v_lshlrev_b32 v16, 16, v20
    v_and_b32 v20, s41, v20
    v_lshlrev_b32 v17, 16, v21
    v_and_b32 v21, s41, v21
    v_lshlrev_b32 v18, 16, v22
    v_and_b32 v22, s41, v22
    v_lshlrev_b32 v19, 16, v23
    v_and_b32 v23, s41, v23
    v_mfma_f32_16x16x32_bf16 v[196:199], a[124:127], v[140:143], v[124:127]
    v_mul_f32_dpp v204, v58, v90 row_ror:13 row_mask:0xf bank_mask:0xf
    v_mul_f32_dpp v205, v62, v94 row_ror:13 row_mask:0xf bank_mask:0xf
    v_mfma_f32_16x16x32_bf16 v[196:199], a[120:123], v[136:139], v[196:199]
    v_mul_f32_dpp v206, v59, v91 row_ror:13 row_mask:0xf bank_mask:0xf
    v_mul_f32_dpp v207, v63, v95 row_ror:13 row_mask:0xf bank_mask:0xf
    v_mfma_f32_16x16x32_bf16 v[196:199], a[116:119], v[132:135], v[196:199]
    v_cvt_pk_bf16_f32 v188, |v192|, |v193|
    v_cvt_pk_bf16_f32 v189, |v194|, |v195|
    v_mfma_f32_16x16x32_bf16 v[196:199], a[112:115], v[128:131], v[196:199]
    buffer_load_dwordx4 v[60:63], v239, s[24:27], 0 offen offset:48
    v_cvt_pk_bf16_f32 v158, v204, v205
    v_cvt_pk_bf16_f32 v159, v206, v207
    v_mfma_f32_16x16x32_bf16 v[192:195], a[0:3], v[144:147], v[96:99]
    v_mul_f32_dpp v204, v0, v0 row_ror:1 row_mask:0xf bank_mask:0xf
    v_mul_f32_dpp v205, v4, v4 row_ror:1 row_mask:0xf bank_mask:0xf
    v_mfma_f32_16x16x32_bf16 v[192:195], a[4:7], v[148:151], v[192:195]
    v_mul_f32_dpp v206, v1, v1 row_ror:1 row_mask:0xf bank_mask:0xf
    v_mul_f32_dpp v207, v5, v5 row_ror:1 row_mask:0xf bank_mask:0xf
    v_mfma_f32_16x16x32_bf16 v[192:195], a[8:11], v[152:155], v[192:195]
    v_cvt_pk_bf16_f32 v190, |v196|, |v197|
    v_cvt_pk_bf16_f32 v191, |v198|, |v199|
    v_mfma_f32_16x16x32_bf16 v[192:195], a[12:15], v[156:159], v[192:195]
    s_waitcnt vmcnt(5)
    v_cvt_pk_bf16_f32 v128, v204, v205
    v_cvt_pk_bf16_f32 v129, v206, v207
    v_smfmac_f32_16x16x64_bf16 v[200:203], a[168:171], v[176:183], v242
    v_lshlrev_b32 v24, 16, v28
    v_smfmac_f32_16x16x64_bf16 v[200:203], a[172:175], v[184:191], v242
    v_and_b32 v28, s41, v28
    v_smfmac_f32_16x16x64_bf16 v[200:203], a[176:179], v[144:151], v242
    v_lshlrev_b32 v25, 16, v29
    v_smfmac_f32_16x16x64_bf16 v[200:203], a[180:183], v[152:159], v242
    v_and_b32 v29, s41, v29
    v_lshlrev_b32 v26, 16, v30
    v_and_b32 v30, s41, v30
    v_lshlrev_b32 v27, 16, v31
    v_and_b32 v31, s41, v31
    v_mfma_f32_16x16x32_bf16 v[196:199], a[28:31], v[156:159], v[100:103]
    v_mul_f32_dpp v204, v2, v2 row_ror:1 row_mask:0xf bank_mask:0xf
    v_mul_f32_dpp v205, v6, v6 row_ror:1 row_mask:0xf bank_mask:0xf
    v_mfma_f32_16x16x32_bf16 v[196:199], a[24:27], v[152:155], v[196:199]
    v_mul_f32_dpp v206, v3, v3 row_ror:1 row_mask:0xf bank_mask:0xf
    v_mul_f32_dpp v207, v7, v7 row_ror:1 row_mask:0xf bank_mask:0xf
    v_mfma_f32_16x16x32_bf16 v[196:199], a[20:23], v[148:151], v[196:199]
    v_cvt_pk_bf16_f32 v176, |v192|, |v193|
    v_cvt_pk_bf16_f32 v177, |v194|, |v195|
    v_mfma_f32_16x16x32_bf16 v[196:199], a[16:19], v[144:147], v[196:199]
    v_cvt_pk_bf16_f32 v130, v204, v205
    v_cvt_pk_bf16_f32 v131, v206, v207
    v_mfma_f32_16x16x32_bf16 v[192:195], a[32:35], v[144:147], v[104:107]
    v_mul_f32_dpp v204, v8, v8 row_ror:1 row_mask:0xf bank_mask:0xf
    v_mul_f32_dpp v205, v12, v12 row_ror:1 row_mask:0xf bank_mask:0xf
    v_mfma_f32_16x16x32_bf16 v[192:195], a[36:39], v[148:151], v[192:195]
    v_mul_f32_dpp v206, v9, v9 row_ror:1 row_mask:0xf bank_mask:0xf
    v_mul_f32_dpp v207, v13, v13 row_ror:1 row_mask:0xf bank_mask:0xf
    v_mfma_f32_16x16x32_bf16 v[192:195], a[40:43], v[152:155], v[192:195]
    v_cvt_pk_bf16_f32 v178, |v196|, |v197|
    v_cvt_pk_bf16_f32 v179, |v198|, |v199|
    v_mfma_f32_16x16x32_bf16 v[192:195], a[44:47], v[156:159], v[192:195]
    v_cvt_pk_bf16_f32 v132, v204, v205
    v_cvt_pk_bf16_f32 v133, v206, v207
    v_mfma_f32_16x16x32_bf16 v[196:199], a[60:63], v[156:159], v[108:111]
    v_mul_f32_dpp v204, v10, v10 row_ror:1 row_mask:0xf bank_mask:0xf
    v_mul_f32_dpp v205, v14, v14 row_ror:1 row_mask:0xf bank_mask:0xf
    v_mfma_f32_16x16x32_bf16 v[196:199], a[56:59], v[152:155], v[196:199]
    v_mul_f32_dpp v206, v11, v11 row_ror:1 row_mask:0xf bank_mask:0xf
    v_mul_f32_dpp v207, v15, v15 row_ror:1 row_mask:0xf bank_mask:0xf
    v_mfma_f32_16x16x32_bf16 v[196:199], a[52:55], v[148:151], v[196:199]
    v_cvt_pk_bf16_f32 v180, |v192|, |v193|
    v_cvt_pk_bf16_f32 v181, |v194|, |v195|
    v_mfma_f32_16x16x32_bf16 v[196:199], a[48:51], v[144:147], v[196:199]
    v_cvt_pk_bf16_f32 v134, v204, v205
    v_cvt_pk_bf16_f32 v135, v206, v207
    v_mfma_f32_16x16x32_bf16 v[192:195], a[64:67], v[144:147], v[112:115]
    v_mul_f32_dpp v204, v16, v16 row_ror:1 row_mask:0xf bank_mask:0xf
    v_mul_f32_dpp v205, v20, v20 row_ror:1 row_mask:0xf bank_mask:0xf
    v_mfma_f32_16x16x32_bf16 v[192:195], a[68:71], v[148:151], v[192:195]
    v_mul_f32_dpp v206, v17, v17 row_ror:1 row_mask:0xf bank_mask:0xf
    v_mul_f32_dpp v207, v21, v21 row_ror:1 row_mask:0xf bank_mask:0xf
    v_mfma_f32_16x16x32_bf16 v[192:195], a[72:75], v[152:155], v[192:195]
    v_cvt_pk_bf16_f32 v182, |v196|, |v197|
    v_cvt_pk_bf16_f32 v183, |v198|, |v199|
    v_mfma_f32_16x16x32_bf16 v[192:195], a[76:79], v[156:159], v[192:195]
    buffer_load_dword v239, v244, s[20:23], s33 offen
    v_cvt_pk_bf16_f32 v136, v204, v205
    v_cvt_pk_bf16_f32 v137, v206, v207
    v_mfma_f32_16x16x32_bf16 v[196:199], a[92:95], v[156:159], v[116:119]
    v_mul_f32_dpp v204, v18, v18 row_ror:1 row_mask:0xf bank_mask:0xf
    v_mul_f32_dpp v205, v22, v22 row_ror:1 row_mask:0xf bank_mask:0xf
    v_mfma_f32_16x16x32_bf16 v[196:199], a[88:91], v[152:155], v[196:199]
    v_mul_f32_dpp v206, v19, v19 row_ror:1 row_mask:0xf bank_mask:0xf
    v_mul_f32_dpp v207, v23, v23 row_ror:1 row_mask:0xf bank_mask:0xf
    v_mfma_f32_16x16x32_bf16 v[196:199], a[84:87], v[148:151], v[196:199]
    v_cvt_pk_bf16_f32 v184, |v192|, |v193|
    v_cvt_pk_bf16_f32 v185, |v194|, |v195|
    v_mfma_f32_16x16x32_bf16 v[196:199], a[80:83], v[144:147], v[196:199]
    v_cvt_pk_bf16_f32 v138, v204, v205
    v_cvt_pk_bf16_f32 v139, v206, v207
    v_mfma_f32_16x16x32_bf16 v[192:195], a[96:99], v[144:147], v[120:123]
    v_mul_f32_dpp v204, v24, v24 row_ror:1 row_mask:0xf bank_mask:0xf
    v_mul_f32_dpp v205, v28, v28 row_ror:1 row_mask:0xf bank_mask:0xf
    v_mfma_f32_16x16x32_bf16 v[192:195], a[100:103], v[148:151], v[192:195]
    v_mul_f32_dpp v206, v25, v25 row_ror:1 row_mask:0xf bank_mask:0xf
    v_mul_f32_dpp v207, v29, v29 row_ror:1 row_mask:0xf bank_mask:0xf
    v_mfma_f32_16x16x32_bf16 v[192:195], a[104:107], v[152:155], v[192:195]
    v_cvt_pk_bf16_f32 v186, |v196|, |v197|
    v_cvt_pk_bf16_f32 v187, |v198|, |v199|
    v_mfma_f32_16x16x32_bf16 v[192:195], a[108:111], v[156:159], v[192:195]
    v_cvt_pk_bf16_f32 v140, v204, v205
    v_cvt_pk_bf16_f32 v141, v206, v207
    v_mfma_f32_16x16x32_bf16 v[196:199], a[124:127], v[156:159], v[124:127]
    v_mul_f32_dpp v204, v26, v26 row_ror:1 row_mask:0xf bank_mask:0xf
    v_mul_f32_dpp v205, v30, v30 row_ror:1 row_mask:0xf bank_mask:0xf
    v_mfma_f32_16x16x32_bf16 v[196:199], a[120:123], v[152:155], v[196:199]
    v_mul_f32_dpp v206, v27, v27 row_ror:1 row_mask:0xf bank_mask:0xf
    v_mul_f32_dpp v207, v31, v31 row_ror:1 row_mask:0xf bank_mask:0xf
    v_mfma_f32_16x16x32_bf16 v[196:199], a[116:119], v[148:151], v[196:199]
    s_bitcmp1_b32 s34, 0
    v_cvt_pk_bf16_f32 v188, |v192|, |v193|
    v_cvt_pk_bf16_f32 v189, |v194|, |v195|
    v_mfma_f32_16x16x32_bf16 v[196:199], a[112:115], v[144:147], v[196:199]
    v_cvt_pk_bf16_f32 v142, v204, v205
    v_cvt_pk_bf16_f32 v143, v206, v207
    s_cbranch_scc1 L_H
    s_add_u32 s34, s34, 1
    s_branch L_T0
.p2align 3
L_H:
    v_mfma_f32_16x16x32_bf16 v[192:195], a[0:3], v[160:163], v[96:99]
    s_nop 0
    s_nop 0
    v_mfma_f32_16x16x32_bf16 v[192:195], a[4:7], v[164:167], v[192:195]
    s_nop 0
    s_nop 0
    v_mfma_f32_16x16x32_bf16 v[192:195], a[8:11], v[168:171], v[192:195]
    s_nop 0
    s_nop 0
    v_mfma_f32_16x16x32_bf16 v[192:195], a[12:15], v[172:175], v[192:195]
    v_cvt_pk_bf16_f32 v190, |v196|, |v197|
    v_cvt_pk_bf16_f32 v191, |v198|, |v199|
    v_smfmac_f32_16x16x64_bf16 v[200:203], a[184:187], v[176:183], v242
    s_nop 0
    v_smfmac_f32_16x16x64_bf16 v[200:203], a[188:191], v[184:191], v242
    v_mfma_f32_16x16x32_bf16 v[196:199], a[28:31], v[172:175], v[100:103]
    s_nop 0
    s_nop 0
    v_mfma_f32_16x16x32_bf16 v[196:199], a[24:27], v[168:171], v[196:199]
    s_nop 0
    s_nop 0
    v_mfma_f32_16x16x32_bf16 v[196:199], a[20:23], v[164:167], v[196:199]
    s_nop 0
    s_nop 0
    v_mfma_f32_16x16x32_bf16 v[196:199], a[16:19], v[160:163], v[196:199]
    v_add_f32 v216, v200, v201
    v_add_f32 v221, v202, v203
    v_mov_b64 v[200:201], 0
    v_mov_b64 v[202:203], 0
    v_cvt_pk_bf16_f32 v176, |v192|, |v193|
    v_cvt_pk_bf16_f32 v177, |v194|, |v195|
    v_smfmac_f32_16x16x64_bf16 v[200:203], a[128:131], v[160:167], v242
    v_cndmask_b32 v216, v216, v208, s[38:39]
    v_smfmac_f32_16x16x64_bf16 v[200:203], a[132:135], v[168:175], v242
    v_max3_f32 v225, v212, v213, v214
    v_mfma_f32_16x16x32_bf16 v[192:195], a[32:35], v[160:163], v[104:107]
    v_max3_f32 v225, v225, v215, v216
    v_mul_f32 v225, s40, v225
    v_mfma_f32_16x16x32_bf16 v[192:195], a[36:39], v[164:167], v[192:195]
    v_fma_f32 v212, v212, s40, -v225
    v_fma_f32 v213, v213, s40, -v225
    v_mfma_f32_16x16x32_bf16 v[192:195], a[40:43], v[168:171], v[192:195]
    v_fma_f32 v214, v214, s40, -v225
    v_fma_f32 v215, v215, s40, -v225
    v_mfma_f32_16x16x32_bf16 v[192:195], a[44:47], v[172:175], v[192:195]
    v_cvt_pk_bf16_f32 v178, |v196|, |v197|
    v_cvt_pk_bf16_f32 v179, |v198|, |v199|
    v_mfma_f32_16x16x32_bf16 v[196:199], a[60:63], v[172:175], v[108:111]
    v_fma_f32 v216, v216, s40, -v225
    s_nop 0
    v_mfma_f32_16x16x32_bf16 v[196:199], a[56:59], v[168:171], v[196:199]
    s_nop 0
    v_exp_f32 v212, v212
    v_mfma_f32_16x16x32_bf16 v[196:199], a[52:55], v[164:167], v[196:199]
    s_nop 0
    v_exp_f32 v213, v213
    v_mfma_f32_16x16x32_bf16 v[196:199], a[48:51], v[160:163], v[196:199]
    v_cvt_pk_bf16_f32 v180, |v192|, |v193|
    v_cvt_pk_bf16_f32 v181, |v194|, |v195|
    v_mfma_f32_16x16x32_bf16 v[192:195], a[64:67], v[160:163], v[112:115]
    s_nop 0
    v_exp_f32 v214, v214
    v_mfma_f32_16x16x32_bf16 v[192:195], a[68:71], v[164:167], v[192:195]
    s_nop 0
    v_exp_f32 v215, v215
    v_mfma_f32_16x16x32_bf16 v[192:195], a[72:75], v[168:171], v[192:195]
    s_nop 0
    v_exp_f32 v216, v216
    v_mfma_f32_16x16x32_bf16 v[192:195], a[76:79], v[172:175], v[192:195]
    v_cvt_pk_bf16_f32 v182, |v196|, |v197|
    v_cvt_pk_bf16_f32 v183, |v198|, |v199|
    v_mfma_f32_16x16x32_bf16 v[196:199], a[92:95], v[172:175], v[116:119]
    v_add_f32 v226, v212, v213
    v_mul_f32 v227, v212, v217
    v_mfma_f32_16x16x32_bf16 v[196:199], a[88:91], v[168:171], v[196:199]
    v_add_f32 v226, v226, v214
    v_add_f32 v226, v226, v215
    v_mfma_f32_16x16x32_bf16 v[196:199], a[84:87], v[164:167], v[196:199]
    v_add_f32 v226, v226, v216
    v_fmac_f32 v227, v213, v218
    v_mfma_f32_16x16x32_bf16 v[196:199], a[80:83], v[160:163], v[196:199]
    v_cvt_pk_bf16_f32 v184, |v192|, |v193|
    v_cvt_pk_bf16_f32 v185, |v194|, |v195|
    v_mfma_f32_16x16x32_bf16 v[192:195], a[96:99], v[160:163], v[120:123]
    v_fmac_f32 v227, v214, v219
    v_fmac_f32 v227, v215, v220
    v_mfma_f32_16x16x32_bf16 v[192:195], a[100:103], v[164:167], v[192:195]
    v_fmac_f32 v227, v216, v221
    s_nop 0
    v_mfma_f32_16x16x32_bf16 v[192:195], a[104:107], v[168:171], v[192:195]
    s_nop 0
    s_nop 0
    v_mfma_f32_16x16x32_bf16 v[192:195], a[108:111], v[172:175], v[192:195]
    v_cvt_pk_bf16_f32 v186, |v196|, |v197|
    v_cvt_pk_bf16_f32 v187, |v198|, |v199|
    v_mfma_f32_16x16x32_bf16 v[196:199], a[124:127], v[172:175], v[124:127]
    s_nop 0
    s_nop 0
    v_mfma_f32_16x16x32_bf16 v[196:199], a[120:123], v[168:171], v[196:199]
    s_nop 0
    s_nop 0
    v_mfma_f32_16x16x32_bf16 v[196:199], a[116:119], v[164:167], v[196:199]
    s_nop 0
    s_nop 0
    v_mfma_f32_16x16x32_bf16 v[196:199], a[112:115], v[160:163], v[196:199]
    v_cvt_pk_bf16_f32 v188, |v192|, |v193|
    v_cvt_pk_bf16_f32 v189, |v194|, |v195|
    s_cmp_eq_u32 s34, 3
    s_cbranch_scc1 L_fin
    s_add_u32 s34, s34, 1
L_T0P:
    v_mfma_f32_16x16x32_bf16 v[192:195], a[0:3], v[128:131], v[96:99]
    v_mul_f32_dpp v204, v0, v0 row_ror:2 row_mask:0xf bank_mask:0xf
    v_mul_f32_dpp v205, v4, v4 row_ror:2 row_mask:0xf bank_mask:0xf
    v_mfma_f32_16x16x32_bf16 v[192:195], a[4:7], v[132:135], v[192:195]
    v_mul_f32_dpp v206, v1, v1 row_ror:2 row_mask:0xf bank_mask:0xf
    v_mul_f32_dpp v207, v5, v5 row_ror:2 row_mask:0xf bank_mask:0xf
    v_mfma_f32_16x16x32_bf16 v[192:195], a[8:11], v[136:139], v[192:195]
    v_cvt_pk_bf16_f32 v190, |v196|, |v197|
    v_cvt_pk_bf16_f32 v191, |v198|, |v199|
    v_mfma_f32_16x16x32_bf16 v[192:195], a[12:15], v[140:143], v[192:195]
    v_cvt_pk_bf16_f32 v144, v204, v205
    v_cvt_pk_bf16_f32 v145, v206, v207
    v_smfmac_f32_16x16x64_bf16 v[200:203], a[136:139], v[176:183], v242
    v_mul_f32_dpp v64, v0, v0 row_ror:8 row_mask:0xf bank_mask:0xf
    v_smfmac_f32_16x16x64_bf16 v[200:203], a[140:143], v[184:191], v242
    v_mul_f32_dpp v65, v1, v1 row_ror:8 row_mask:0xf bank_mask:0xf
    v_mfma_f32_16x16x32_bf16 v[196:199], a[28:31], v[140:143], v[100:103]
    v_mul_f32_dpp v204, v2, v2 row_ror:2 row_mask:0xf bank_mask:0xf
    v_mul_f32_dpp v205, v6, v6 row_ror:2 row_mask:0xf bank_mask:0xf
    v_mfma_f32_16x16x32_bf16 v[196:199], a[24:27], v[136:139], v[196:199]
    v_mul_f32_dpp v206, v3, v3 row_ror:2 row_mask:0xf bank_mask:0xf
    v_mul_f32_dpp v207, v7, v7 row_ror:2 row_mask:0xf bank_mask:0xf
    v_mfma_f32_16x16x32_bf16 v[196:199], a[20:23], v[132:135], v[196:199]
    v_cvt_pk_bf16_f32 v176, |v192|, |v193|
    v_cvt_pk_bf16_f32 v177, |v194|, |v195|
    v_mfma_f32_16x16x32_bf16 v[196:199], a[16:19], v[128:131], v[196:199]
    v_add_f32 v234, v200, v201
    v_add_f32 v235, v202, v203
    v_mov_b64 v[200:201], 0
    v_mov_b64 v[202:203], 0
    v_cvt_pk_bf16_f32 v146, v204, v205
    v_cvt_pk_bf16_f32 v147, v206, v207
    v_smfmac_f32_16x16x64_bf16 v[200:203], a[128:131], v[128:135], v242
    v_mov_b64 v[228:229], v[222:223]
    v_smfmac_f32_16x16x64_bf16 v[200:203], a[132:135], v[136:143], v242
    v_mov_b64 v[230:231], v[224:225]
    v_mov_b64 v[232:233], v[226:227]
    v_mfma_f32_16x16x32_bf16 v[192:195], a[32:35], v[128:131], v[104:107]
    v_mul_f32_dpp v204, v8, v8 row_ror:2 row_mask:0xf bank_mask:0xf
    v_mul_f32_dpp v205, v12, v12 row_ror:2 row_mask:0xf bank_mask:0xf
    v_mfma_f32_16x16x32_bf16 v[192:195], a[36:39], v[132:135], v[192:195]
    v_mul_f32_dpp v206, v9, v9 row_ror:2 row_mask:0xf bank_mask:0xf
    v_mul_f32_dpp v207, v13, v13 row_ror:2 row_mask:0xf bank_mask:0xf
    v_mfma_f32_16x16x32_bf16 v[192:195], a[40:43], v[136:139], v[192:195]
    v_cvt_pk_bf16_f32 v178, |v196|, |v197|
    v_cvt_pk_bf16_f32 v179, |v198|, |v199|
    v_mfma_f32_16x16x32_bf16 v[192:195], a[44:47], v[140:143], v[192:195]
    v_cvt_pk_bf16_f32 v148, v204, v205
    v_cvt_pk_bf16_f32 v149, v206, v207
    v_mfma_f32_16x16x32_bf16 v[196:199], a[60:63], v[140:143], v[108:111]
    v_mul_f32_dpp v204, v10, v10 row_ror:2 row_mask:0xf bank_mask:0xf
    v_mul_f32_dpp v205, v14, v14 row_ror:2 row_mask:0xf bank_mask:0xf
    v_mfma_f32_16x16x32_bf16 v[196:199], a[56:59], v[136:139], v[196:199]
    v_mul_f32_dpp v206, v11, v11 row_ror:2 row_mask:0xf bank_mask:0xf
    v_mul_f32_dpp v207, v15, v15 row_ror:2 row_mask:0xf bank_mask:0xf
    v_mfma_f32_16x16x32_bf16 v[196:199], a[52:55], v[132:135], v[196:199]
    v_cvt_pk_bf16_f32 v180, |v192|, |v193|
    v_cvt_pk_bf16_f32 v181, |v194|, |v195|
    v_mfma_f32_16x16x32_bf16 v[196:199], a[48:51], v[128:131], v[196:199]
    v_cvt_pk_bf16_f32 v150, v204, v205
    v_cvt_pk_bf16_f32 v151, v206, v207
    v_mfma_f32_16x16x32_bf16 v[192:195], a[64:67], v[128:131], v[112:115]
    v_mul_f32_dpp v204, v16, v16 row_ror:2 row_mask:0xf bank_mask:0xf
    v_mul_f32_dpp v205, v20, v20 row_ror:2 row_mask:0xf bank_mask:0xf
    v_mfma_f32_16x16x32_bf16 v[192:195], a[68:71], v[132:135], v[192:195]
    v_mul_f32_dpp v206, v17, v17 row_ror:2 row_mask:0xf bank_mask:0xf
    v_mul_f32_dpp v207, v21, v21 row_ror:2 row_mask:0xf bank_mask:0xf
    v_mfma_f32_16x16x32_bf16 v[192:195], a[72:75], v[136:139], v[192:195]
    v_cvt_pk_bf16_f32 v182, |v196|, |v197|
    v_cvt_pk_bf16_f32 v183, |v198|, |v199|
    v_mfma_f32_16x16x32_bf16 v[192:195], a[76:79], v[140:143], v[192:195]
    v_cvt_pk_bf16_f32 v152, v204, v205
    v_cvt_pk_bf16_f32 v153, v206, v207
    v_mfma_f32_16x16x32_bf16 v[196:199], a[92:95], v[140:143], v[116:119]
    v_mul_f32_dpp v204, v18, v18 row_ror:2 row_mask:0xf bank_mask:0xf
    v_mul_f32_dpp v205, v22, v22 row_ror:2 row_mask:0xf bank_mask:0xf
    v_mfma_f32_16x16x32_bf16 v[196:199], a[88:91], v[136:139], v[196:199]
    v_mul_f32_dpp v206, v19, v19 row_ror:2 row_mask:0xf bank_mask:0xf
    v_mul_f32_dpp v207, v23, v23 row_ror:2 row_mask:0xf bank_mask:0xf
    v_mfma_f32_16x16x32_bf16 v[196:199], a[84:87], v[132:135], v[196:199]
    v_cvt_pk_bf16_f32 v184, |v192|, |v193|
    v_cvt_pk_bf16_f32 v185, |v194|, |v195|
    v_mfma_f32_16x16x32_bf16 v[196:199], a[80:83], v[128:131], v[196:199]
    v_cvt_pk_bf16_f32 v154, v204, v205
    v_cvt_pk_bf16_f32 v155, v206, v207
    v_mfma_f32_16x16x32_bf16 v[192:195], a[96:99], v[128:131], v[120:123]
    v_mul_f32_dpp v204, v24, v24 row_ror:2 row_mask:0xf bank_mask:0xf
    v_mul_f32_dpp v205, v28, v28 row_ror:2 row_mask:0xf bank_mask:0xf
    v_mfma_f32_16x16x32_bf16 v[192:195], a[100:103], v[132:135], v[192:195]
    v_mul_f32_dpp v206, v25, v25 row_ror:2 row_mask:0xf bank_mask:0xf
    v_mul_f32_dpp v207, v29, v29 row_ror:2 row_mask:0xf bank_mask:0xf
    v_mfma_f32_16x16x32_bf16 v[192:195], a[104:107], v[136:139], v[192:195]
    v_cvt_pk_bf16_f32 v186, |v196|, |v197|
    v_cvt_pk_bf16_f32 v187, |v198|, |v199|
    v_mfma_f32_16x16x32_bf16 v[192:195], a[108:111], v[140:143], v[192:195]
    v_cvt_pk_bf16_f32 v156, v204, v205
    v_cvt_pk_bf16_f32 v157, v206, v207
    v_mfma_f32_16x16x32_bf16 v[196:199], a[124:127], v[140:143], v[124:127]
    v_mul_f32_dpp v204, v26, v26 row_ror:2 row_mask:0xf bank_mask:0xf
    v_mul_f32_dpp v205, v30, v30 row_ror:2 row_mask:0xf bank_mask:0xf
    v_mfma_f32_16x16x32_bf16 v[196:199], a[120:123], v[136:139], v[196:199]
    v_mul_f32_dpp v206, v27, v27 row_ror:2 row_mask:0xf bank_mask:0xf
    v_mul_f32_dpp v207, v31, v31 row_ror:2 row_mask:0xf bank_mask:0xf
    v_mfma_f32_16x16x32_bf16 v[196:199], a[116:119], v[132:135], v[196:199]
    v_cvt_pk_bf16_f32 v188, |v192|, |v193|
    v_cvt_pk_bf16_f32 v189, |v194|, |v195|
    v_mfma_f32_16x16x32_bf16 v[196:199], a[112:115], v[128:131], v[196:199]
    v_cvt_pk_bf16_f32 v158, v204, v205
    v_cvt_pk_bf16_f32 v159, v206, v207
    s_branch L_T1
L_fin:
    s_nop 5
    v_cvt_pk_bf16_f32 v190, |v196|, |v197|
    v_cvt_pk_bf16_f32 v191, |v198|, |v199|
    v_smfmac_f32_16x16x64_bf16 v[200:203], a[136:139], v[176:183], v242
    s_nop 0
    v_smfmac_f32_16x16x64_bf16 v[200:203], a[140:143], v[184:191], v242
    s_mov_b64 s[44:45], 0xff
    s_mov_b64 s[46:47], 0xff00
    v_mul_f32 v234, s40, v234
    v_cndmask_b32 v0, v208, v234, s[44:45]
    v_cndmask_b32 v1, v208, v234, s[46:47]
    v_max_f32 v4, v0, v228
    v_max_f32 v5, v1, v231
    v_lshrrev_b32 v20, 6, v246
    v_add_f32 v236, v200, v201
    v_add_f32 v237, v202, v203
    v_permlane32_swap_b32 v4, v5
    v_mul_f32 v236, s40, v236
    v_cndmask_b32 v2, v208, v236, s[44:45]
    v_cndmask_b32 v3, v208, v236, s[46:47]
    v_max_f32 v6, v2, v222
    v_max_f32 v7, v3, v225
    v_max_f32 v4, v4, v5
    v_and_b32 v21, 1, v20
    v_permlane32_swap_b32 v6, v7
    v_max_f32 v6, v6, v7
    v_lshlrev_b32 v21, 2, v21
    v_and_b32 v20, 2, v20
    v_permlane16_swap_b32 v4, v6
    v_max_f32 v4, v4, v6
    v_add_u32 v20, v20, v21
    s_lshl_b32 s48, s42, 3
    v_max_f32_dpp v4, v4, v4 row_ror:8 row_mask:0xf bank_mask:0xf
    s_nop 1
    v_max_f32_dpp v4, v4, v4 row_ror:4 row_mask:0xf bank_mask:0xf
    s_nop 1
    v_max_f32_dpp v4, v4, v4 row_ror:2 row_mask:0xf bank_mask:0xf
    s_nop 1
    v_max_f32_dpp v4, v4, v4 row_ror:1 row_mask:0xf bank_mask:0xf
    s_nop 1
    v_readlane_b32 s60, v4, 0
    v_readlane_b32 s61, v4, 32
    v_readlane_b32 s62, v4, 16
    v_readlane_b32 s63, v4, 48
    v_subrev_f32 v16, s60, v228
    v_subrev_f32 v0, s60, v0
    v_subrev_f32 v17, s61, v231
    v_subrev_f32 v1, s61, v1
    v_subrev_f32 v18, s62, v222
    v_subrev_f32 v2, s62, v2
    v_subrev_f32 v19, s63, v225
    v_subrev_f32 v3, s63, v3
    v_exp_f32 v16, v16
    v_exp_f32 v0, v0
    v_exp_f32 v17, v17
    v_exp_f32 v1, v1
    v_exp_f32 v18, v18
    v_exp_f32 v2, v2
    v_exp_f32 v19, v19
    v_exp_f32 v3, v3
    v_mul_f32 v12, v230, v16
    v_fma_f32 v8, v229, v16, v0
    v_mul_f32 v13, v233, v17
    v_fma_f32 v9, v232, v17, v1
    v_mul_f32 v14, v224, v18
    v_fma_f32 v10, v223, v18, v2
    v_mul_f32 v15, v227, v19
    v_fma_f32 v11, v226, v19, v3
    v_fmac_f32 v12, v0, v235
    v_fmac_f32 v13, v1, v235
    v_fmac_f32 v14, v2, v237
    v_fmac_f32 v15, v3, v237
    v_permlane32_swap_b32 v8, v9
    v_permlane32_swap_b32 v10, v11
    v_permlane32_swap_b32 v12, v13
    v_permlane32_swap_b32 v14, v15
    v_add_f32 v8, v8, v9
    v_add_f32 v10, v10, v11
    v_add_f32 v12, v12, v13
    v_add_f32 v14, v14, v15
    v_permlane16_swap_b32 v8, v10
    s_nop 0
    v_permlane16_swap_b32 v12, v14
    v_add_f32 v8, v8, v10
    v_add_f32 v12, v12, v14
    s_nop 0
    v_add_f32_dpp v8, v8, v8 row_ror:8 row_mask:0xf bank_mask:0xf
    v_add_f32_dpp v12, v12, v12 row_ror:8 row_mask:0xf bank_mask:0xf
    s_nop 0
    v_add_f32_dpp v8, v8, v8 row_ror:4 row_mask:0xf bank_mask:0xf
    v_add_f32_dpp v12, v12, v12 row_ror:4 row_mask:0xf bank_mask:0xf
    s_nop 0
    v_add_f32_dpp v8, v8, v8 row_ror:2 row_mask:0xf bank_mask:0xf
    v_add_f32_dpp v12, v12, v12 row_ror:2 row_mask:0xf bank_mask:0xf
    s_nop 0
    v_add_f32_dpp v8, v8, v8 row_ror:1 row_mask:0xf bank_mask:0xf
    v_add_f32_dpp v12, v12, v12 row_ror:1 row_mask:0xf bank_mask:0xf
    s_nop 0
    v_rcp_f32 v8, v8
    s_mov_b32 s44, 0x00010001
    s_mov_b32 s45, 0x00010001
    v_mul_f32 v12, v12, v8
    v_cvt_pk_bf16_f32 v12, v12, v12
    s_mov_b64 exec, s[44:45]
    buffer_store_short v12, v20, s[28:31], s48 offen
L_end:
    s_endpgm
.fill 1024, 4, 0xbf800000
.section .rodata,"a"
.p2align 6
.amdhsa_kernel standalone__factorization_afm__recsys_kernel
  .amdhsa_next_free_vgpr 448
  .amdhsa_next_free_sgpr 96
  .amdhsa_accum_offset 256
  .amdhsa_group_segment_fixed_size 0
  .amdhsa_kernarg_size 88
  .amdhsa_user_sgpr_count 2
  .amdhsa_user_sgpr_kernarg_segment_ptr 1
  .amdhsa_system_sgpr_workgroup_id_x 1
  .amdhsa_float_denorm_mode_32 3
.end_amdhsa_kernel
```
